```python
import torch

def _softmax(x, axis=-1):
    return torch.softmax(x, dim=axis)
def _gelu(x):
    return torch.nn.functional.gelu(x, approximate="tanh")
def _silu(x):
    return torch.nn.functional.silu(x)
def _sigmoid(x):
    return torch.sigmoid(x)
def _layernorm(x, axis=-1, eps=1e-5):
    m = x.mean(dim=axis, keepdim=True)
    v = x.var(dim=axis, keepdim=True, unbiased=False)
    return (x - m) / torch.sqrt(v + eps)
def _scatter_add(tgt, idx, src, axis=0):
    return tgt.clone().index_add_(axis, idx, src)
def _segment_sum(src, seg, n):
    out = torch.zeros((n,) + src.shape[1:], dtype=src.dtype)
    return out.index_add_(0, seg, src)
def _pad(x, pw):
    flat = tuple(v for pair in reversed(pw) for v in pair)
    return torch.nn.functional.pad(x, flat)

kernel_name = 'standalone__mha_block__prompt'

def setup_inputs():

    _w = (lambda a: (lambda t: t.to(torch.bfloat16) if t.is_floating_point() else t)(torch.as_tensor(a)))
    B, S, D, H = 1, 2048, 448, 16
    return {
        "x": _w((lambda *s: torch.randn(*s, dtype=torch.bfloat16) * 0.2)(B, S, D)),
        "wqkv": _w((lambda *s: torch.randn(*s, dtype=torch.bfloat16) * 0.2)(D, 3 * D)),
        "wo": _w((lambda *s: torch.randn(*s, dtype=torch.bfloat16) * 0.05)(D, D)),
    }

def reference(x, wqkv, wo):
    B, S, D = x.shape
    H = 16
    Dh = D // H
    qkv = (lambda x, *d: x.permute(*d))((x @ wqkv).reshape(B, S, 3, H, Dh), 2, 0, 3, 1, 4)
    q, k, v = qkv[0], qkv[1], qkv[2]
    scores = torch.einsum("bhqd,bhkd->bhqk", q, k) * (Dh ** -0.5)
    p = _softmax(scores, axis=-1)
    o = torch.einsum("bhqk,bhkd->bhqd", p, v)
    return (lambda x, *d: x.permute(*d))(o, 0, 2, 1, 3).reshape(B, S, D) @ wo
```

```asm
; @launch grid=(256,1,1) block=(512,1,1) lds=163840
.amdgcn_target "amdgcn-amd-amdhsa--gfx950"
.text
.globl standalone__mha_block__prompt_kernel
.p2align 8
.type standalone__mha_block__prompt_kernel,@function
standalone__mha_block__prompt_kernel:
  s_cmp_ge_u32 s2, 256
  s_cbranch_scc1 L_EXIT
  s_load_dwordx4 s[16:19], s[0:1], 0
  s_load_dwordx4 s[4:7], s[0:1], 32
  s_load_dwordx4 s[52:55], s[0:1], 16
  v_lshrrev_b32 v1, 6, v0
  v_and_b32 v2, 63, v0
  v_readfirstlane_b32 s3, v1
  s_and_b32 s24, s2, 3
  s_lshl_b32 s24, s24, 2
  s_bfe_u32 s25, s2, 0x20003
  s_add_u32 s24, s24, s25
  s_bfe_u32 s25, s2, 0x10002
  s_lshl_b32 s25, s25, 3
  s_lshr_b32 s20, s2, 5
  s_add_u32 s25, s25, s20
  s_cmp_ge_u32 s24, 8
  s_mov_b32 s20, 0x65432e10
  s_cselect_b32 s20, 0xdcfba987, s20
  s_and_b32 s21, s24, 7
  s_lshl_b32 s21, s21, 2
  s_lshr_b32 s22, s20, s21
  s_and_b32 s22, s22, 15
  s_and_b32 s39, s24, 3
  s_lshl_b32 s39, s39, 1
  s_add_u32 s39, s39, s25
  s_mul_i32 s20, s39, 37
  s_lshr_b32 s20, s20, 8
  s_mul_i32 s20, s20, 7
  s_sub_u32 s39, s39, s20
  s_cmp_lt_u32 s3, 4
  s_cbranch_scc1 L_CWAVE
  s_setprio 3
  s_sub_u32 s26, s3, 4
  v_lshrrev_b32 v3, 3, v2
  v_and_b32 v4, 7, v2
  v_lshrrev_b32 v5, 1, v3
  s_and_b32 s27, s26, 1
  s_lshl_b32 s27, s27, 2
  v_add_u32 v7, s27, v5
  v_and_b32 v7, 7, v7
  v_xor_b32 v7, v4, v7
  v_and_b32 v5, 1, v5
  v_lshlrev_b32 v5, 2, v5
  v_xor_b32 v5, v4, v5
  v_mul_u32_u24 v6, 2688, v3
  v_lshl_add_u32 v6, v5, 4, v6
  v_mul_u32_u24 v3, 896, v3
  v_lshl_add_u32 v3, v7, 4, v3
  v_lshlrev_b32 v9, 4, v2
  s_lshl_b32 s36, s25, 7
  s_lshl_b32 s27, s26, 3
  s_add_u32 s36, s36, s27
  s_mul_i32 s36, s36, 896
  s_mul_i32 s44, s26, 21504
  s_min_u32 s27, s22, 13
  s_lshl_b32 s27, s27, 7
  s_add_u32 s44, s44, s27
  s_add_u32 s44, s44, 896
  s_mul_i32 s45, s24, 28672
  s_lshl_b32 s27, s26, 10
  s_add_u32 s45, s45, s27
  s_sub_u32 s59, s22, 14
  s_lshl_b32 s59, s59, 4
  s_add_u32 s59, s59, s25
  s_and_b32 s59, s59, 31
  s_mov_b32 s37, s59
  s_min_u32 s59, s59, 27
  s_lshl_b32 s59, s59, 4
  s_add_u32 s59, s59, s26
  s_mul_i32 s59, s59, 2688
  s_lshl_b32 s38, s26, 10
  s_waitcnt lgkmcnt(0)
  s_add_u32 s56, s6, 8586240
  s_addc_u32 s57, s7, 0
  s_load_dword s63, s[56:57], 0
  s_mov_b32 s28, s16
  s_mov_b32 s29, s17
  s_mov_b32 s30, 1835008
  s_mov_b32 s31, 0x00020000
  s_mov_b32 s32, s18
  s_mov_b32 s33, s19
  s_mov_b32 s34, 1204224
  s_mov_b32 s35, 0x00020000
  s_mov_b32 s8, s6
  s_mov_b32 s9, s7
  s_mov_b32 s10, 8781824
  s_mov_b32 s11, 0x00020000
  s_cmp_ge_u32 s22, 14
  s_cbranch_scc1 L_LRPK
  s_add_u32 s40, s39, 0
  s_cmp_ge_u32 s40, 7
  s_cselect_b32 s41, 7, 0
  s_sub_u32 s40, s40, s41
  s_mul_i32 s41, s40, 172032
  s_add_u32 s41, s41, s44
  s_add_u32 s42, s38, 114688
  s_mov_b32 m0, s42
  s_add_u32 s43, s41, 0
  buffer_load_dwordx4 v6, s[32:35], s43 offen lds
  s_add_u32 s42, s38, 118784
  s_mov_b32 m0, s42
  s_add_u32 s43, s41, 86016
  buffer_load_dwordx4 v6, s[32:35], s43 offen lds
  s_lshl_b32 s41, s40, 7
  s_add_u32 s41, s41, s36
  s_add_u32 s42, s38, 0
  s_mov_b32 m0, s42
  s_add_u32 s43, s41, 0
  buffer_load_dwordx4 v3, s[28:31], s43 offen lds
  s_add_u32 s42, s38, 4096
  s_mov_b32 m0, s42
  s_add_u32 s43, s41, 28672
  buffer_load_dwordx4 v3, s[28:31], s43 offen lds
  s_add_u32 s40, s39, 1
  s_cmp_ge_u32 s40, 7
  s_cselect_b32 s41, 7, 0
  s_sub_u32 s40, s40, s41
  s_mul_i32 s41, s40, 172032
  s_add_u32 s41, s41, s44
  s_add_u32 s42, s38, 122880
  s_mov_b32 m0, s42
  s_add_u32 s43, s41, 0
  buffer_load_dwordx4 v6, s[32:35], s43 offen lds
  s_add_u32 s42, s38, 126976
  s_mov_b32 m0, s42
  s_add_u32 s43, s41, 86016
  buffer_load_dwordx4 v6, s[32:35], s43 offen lds
  s_lshl_b32 s41, s40, 7
  s_add_u32 s41, s41, s36
  s_add_u32 s42, s38, 16384
  s_mov_b32 m0, s42
  s_add_u32 s43, s41, 0
  buffer_load_dwordx4 v3, s[28:31], s43 offen lds
  s_add_u32 s42, s38, 20480
  s_mov_b32 m0, s42
  s_add_u32 s43, s41, 28672
  buffer_load_dwordx4 v3, s[28:31], s43 offen lds
  s_add_u32 s40, s39, 2
  s_cmp_ge_u32 s40, 7
  s_cselect_b32 s41, 7, 0
  s_sub_u32 s40, s40, s41
  s_mul_i32 s41, s40, 172032
  s_add_u32 s41, s41, s44
  s_add_u32 s42, s38, 131072
  s_mov_b32 m0, s42
  s_add_u32 s43, s41, 0
  buffer_load_dwordx4 v6, s[32:35], s43 offen lds
  s_add_u32 s42, s38, 135168
  s_mov_b32 m0, s42
  s_add_u32 s43, s41, 86016
  buffer_load_dwordx4 v6, s[32:35], s43 offen lds
  s_lshl_b32 s41, s40, 7
  s_add_u32 s41, s41, s36
  s_add_u32 s42, s38, 32768
  s_mov_b32 m0, s42
  s_add_u32 s43, s41, 0
  buffer_load_dwordx4 v3, s[28:31], s43 offen lds
  s_add_u32 s42, s38, 36864
  s_mov_b32 m0, s42
  s_add_u32 s43, s41, 28672
  buffer_load_dwordx4 v3, s[28:31], s43 offen lds
  s_add_u32 s40, s39, 3
  s_cmp_ge_u32 s40, 7
  s_cselect_b32 s41, 7, 0
  s_sub_u32 s40, s40, s41
  s_mul_i32 s41, s40, 172032
  s_add_u32 s41, s41, s44
  s_add_u32 s42, s38, 139264
  s_mov_b32 m0, s42
  s_add_u32 s43, s41, 0
  buffer_load_dwordx4 v6, s[32:35], s43 offen lds
  s_add_u32 s42, s38, 143360
  s_mov_b32 m0, s42
  s_add_u32 s43, s41, 86016
  buffer_load_dwordx4 v6, s[32:35], s43 offen lds
  s_lshl_b32 s41, s40, 7
  s_add_u32 s41, s41, s36
  s_add_u32 s42, s38, 49152
  s_mov_b32 m0, s42
  s_add_u32 s43, s41, 0
  buffer_load_dwordx4 v3, s[28:31], s43 offen lds
  s_add_u32 s42, s38, 53248
  s_mov_b32 m0, s42
  s_add_u32 s43, s41, 28672
  buffer_load_dwordx4 v3, s[28:31], s43 offen lds
  s_lshr_b32 s20, s2, 2
  s_and_b32 s21, s2, 3
  s_waitcnt lgkmcnt(0)
  s_add_u32 s63, s63, 0x9e3779b8
  v_bfe_u32 v16, v2, 5, 1
  v_bfe_u32 v17, v2, 4, 1
  v_and_b32 v18, 15, v2
  s_mul_i32 s27, s24, 28
  v_mul_u32_u24 v17, 27, v17
  v_add_u32 v17, s27, v17
  v_lshrrev_b32 v17, 6, v17
  v_mul_u32_u24 v16, 7, v16
  v_add_u32 v16, v16, v17
  v_lshl_add_u32 v16, v16, 4, v18
  v_lshlrev_b32 v249, 8, v16
  v_and_b32 v17, 31, v2
  v_add_u32 v17, 224, v17
  v_lshlrev_b32 v11, 8, v17
  v_mov_b32 v10, 1
  v_mov_b32 v12, s63
  v_and_b32 v14, 3, v2
  v_lshlrev_b32 v14, 7, v14
  v_and_b32 v15, 7, v2
  v_lshlrev_b32 v15, 9, v15
  s_lshl_b32 s49, s26, 7
  s_add_u32 s49, s49, 8589312
  s_lshr_b32 s27, s24, 2
  s_lshl_b32 s27, s27, 12
  s_add_u32 s49, s49, s27
  s_lshl_b32 s51, s22, 4
  s_add_u32 s51, s51, s25
  s_lshl_b32 s51, s51, 8
  s_add_u32 s51, s51, 8388608
  v_lshrrev_b32 v16, 4, v2
  v_and_b32 v17, 15, v2
  v_lshlrev_b32 v18, 2, v16
  v_xor_b32 v17, v17, v18
  v_mul_u32_u24 v16, 896, v16
  v_lshl_add_u32 v16, v17, 4, v16
  s_lshl_b32 s27, s21, 4
  v_add_u32 v17, s27, v17
  v_mov_b32 v18, 0x40000000
  v_cmp_le_u32 vcc, 56, v17
  s_nop 1
  v_cndmask_b32 v251, v16, v18, vcc
  s_mul_i32 s46, s26, 15360
  s_add_u32 s46, s46, 0
  v_and_b32 v16, 15, v2
  v_lshrrev_b32 v17, 2, v16
  v_bfe_u32 v18, v2, 4, 1
  v_lshlrev_b32 v18, 1, v18
  v_bfe_u32 v19, v16, 1, 1
  v_add_u32 v18, v18, v19
  v_lshrrev_b32 v21, 5, v2
  v_lshl_add_u32 v19, v21, 2, v17
  v_lshlrev_b32 v20, 8, v19
  v_lshl_add_u32 v20, v18, 4, v20
  v_and_b32 v19, 1, v16
  v_lshl_add_u32 v20, v19, 3, v20
  v_add_u32 v20, s46, v20
  s_add_u32 s27, s26, 0
  s_and_b32 s27, s27, 3
  v_xor_b32 v19, s27, v17
  v_lshl_add_u32 v252, v19, 6, v20
  s_add_u32 s27, s26, 1
  s_and_b32 s27, s27, 3
  v_xor_b32 v19, s27, v17
  v_lshl_add_u32 v253, v19, 6, v20
  s_add_u32 s27, s26, 2
  s_and_b32 s27, s27, 3
  v_xor_b32 v19, s27, v17
  v_lshl_add_u32 v254, v19, 6, v20
  s_add_u32 s27, s26, 3
  s_and_b32 s27, s27, 3
  v_xor_b32 v19, s27, v17
  v_lshl_add_u32 v255, v19, 6, v20
  v_lshlrev_b32 v240, 4, v2
  s_add_u32 s27, s26, 1
  s_and_b32 s27, s27, 3
  s_mul_i32 s27, s27, 12288
  s_add_u32 s27, s27, 0
  v_add_u32 v241, s27, v240
  s_add_u32 s27, s26, 2
  s_and_b32 s27, s27, 3
  s_mul_i32 s27, s27, 12288
  s_add_u32 s27, s27, 4096
  v_add_u32 v242, s27, v240
  s_add_u32 s27, s26, 3
  s_and_b32 s27, s27, 3
  s_mul_i32 s27, s27, 12288
  s_add_u32 s27, s27, 8192
  v_add_u32 v243, s27, v240
  s_mul_i32 s27, s26, 12288
  s_add_u32 s27, s27, 0
  v_add_u32 v244, s27, v240
  v_add_u32 v245, 4096, v240
  s_lshl_b32 s46, s20, 15
  s_lshl_b32 s27, s26, 13
  s_add_u32 s46, s46, s27
  s_add_u32 s46, s46, 6291456
  s_lshl_b32 s47, s20, 2
  s_add_u32 s47, s47, s26
  s_lshl_b32 s47, s47, 9
  s_add_u32 s47, s47, 8454144
  v_and_b32 v246, 31, v2
  v_mul_u32_u24 v246, 896, v246
  v_lshl_add_u32 v246, v21, 4, v246
  s_mul_i32 s48, s20, 28672
  s_lshl_b32 s27, s21, 8
  s_add_u32 s48, s48, s27
  s_lshl_b32 s27, s26, 6
  s_add_u32 s48, s48, s27
  v_mov_b32 v247, 155648
  v_mov_b32 v248, 0
  v_mov_b32 v176, 0
  v_mov_b32 v177, 0
  v_mov_b32 v178, 0
  v_mov_b32 v179, 0
  v_mov_b32 v180, 0
  v_mov_b32 v181, 0
  v_mov_b32 v182, 0
  v_mov_b32 v183, 0
  v_mov_b32 v184, 0
  v_mov_b32 v185, 0
  v_mov_b32 v186, 0
  v_mov_b32 v187, 0
  v_mov_b32 v188, 0
  v_mov_b32 v189, 0
  v_mov_b32 v190, 0
  v_mov_b32 v191, 0
  v_mov_b32 v192, 0
  v_mov_b32 v193, 0
  v_mov_b32 v194, 0
  v_mov_b32 v195, 0
  v_mov_b32 v196, 0
  v_mov_b32 v197, 0
  v_mov_b32 v198, 0
  v_mov_b32 v199, 0
  v_mov_b32 v200, 0
  v_mov_b32 v201, 0
  v_mov_b32 v202, 0
  v_mov_b32 v203, 0
  v_mov_b32 v204, 0
  v_mov_b32 v205, 0
  v_mov_b32 v206, 0
  v_mov_b32 v207, 0
  v_mov_b32 v208, 0
  v_mov_b32 v209, 0
  v_mov_b32 v210, 0
  v_mov_b32 v211, 0
  v_mov_b32 v212, 0
  v_mov_b32 v213, 0
  v_mov_b32 v214, 0
  v_mov_b32 v215, 0
  v_mov_b32 v216, 0
  v_mov_b32 v217, 0
  v_mov_b32 v218, 0
  v_mov_b32 v219, 0
  v_mov_b32 v220, 0
  v_mov_b32 v221, 0
  v_mov_b32 v222, 0
  v_mov_b32 v223, 0
  v_mov_b32 v224, 0
  v_mov_b32 v225, 0
  v_mov_b32 v226, 0
  v_mov_b32 v227, 0
  v_mov_b32 v228, 0
  v_mov_b32 v229, 0
  v_mov_b32 v230, 0
  v_mov_b32 v231, 0
  v_mov_b32 v232, 0
  v_mov_b32 v233, 0
  v_mov_b32 v234, 0
  v_mov_b32 v235, 0
  v_mov_b32 v236, 0
  v_mov_b32 v237, 0
  v_mov_b32 v238, 0
  v_mov_b32 v239, 0
  s_waitcnt vmcnt(12)
  s_barrier
  s_add_u32 s40, s39, 4
  s_cmp_ge_u32 s40, 7
  s_cselect_b32 s41, 7, 0
  s_sub_u32 s40, s40, s41
  s_mul_i32 s41, s40, 172032
  s_add_u32 s41, s41, s44
  s_add_u32 s42, s38, 147456
  s_mov_b32 m0, s42
  s_add_u32 s43, s41, 0
  buffer_load_dwordx4 v6, s[32:35], s43 offen lds
  s_add_u32 s42, s38, 151552
  s_mov_b32 m0, s42
  s_add_u32 s43, s41, 86016
  buffer_load_dwordx4 v6, s[32:35], s43 offen lds
  s_lshl_b32 s41, s40, 7
  s_add_u32 s41, s41, s36
  s_add_u32 s42, s38, 65536
  s_mov_b32 m0, s42
  s_add_u32 s43, s41, 0
  buffer_load_dwordx4 v3, s[28:31], s43 offen lds
  s_add_u32 s42, s38, 69632
  s_mov_b32 m0, s42
  s_add_u32 s43, s41, 28672
  buffer_load_dwordx4 v3, s[28:31], s43 offen lds
  s_waitcnt vmcnt(12)
  s_barrier
  s_add_u32 s40, s39, 5
  s_cmp_ge_u32 s40, 7
  s_cselect_b32 s41, 7, 0
  s_sub_u32 s40, s40, s41
  s_mul_i32 s41, s40, 172032
  s_add_u32 s41, s41, s44
  s_add_u32 s42, s38, 114688
  s_mov_b32 m0, s42
  s_add_u32 s43, s41, 0
  buffer_load_dwordx4 v6, s[32:35], s43 offen lds
  s_add_u32 s42, s38, 118784
  s_mov_b32 m0, s42
  s_add_u32 s43, s41, 86016
  buffer_load_dwordx4 v6, s[32:35], s43 offen lds
  s_lshl_b32 s41, s40, 7
  s_add_u32 s41, s41, s36
  s_add_u32 s42, s38, 81920
  s_mov_b32 m0, s42
  s_add_u32 s43, s41, 0
  buffer_load_dwordx4 v3, s[28:31], s43 offen lds
  s_add_u32 s42, s38, 86016
  s_mov_b32 m0, s42
  s_add_u32 s43, s41, 28672
  buffer_load_dwordx4 v3, s[28:31], s43 offen lds
  s_waitcnt vmcnt(12)
  s_barrier
  s_add_u32 s40, s39, 6
  s_cmp_ge_u32 s40, 7
  s_cselect_b32 s41, 7, 0
  s_sub_u32 s40, s40, s41
  s_mul_i32 s41, s40, 172032
  s_add_u32 s41, s41, s44
  s_add_u32 s42, s38, 122880
  s_mov_b32 m0, s42
  s_add_u32 s43, s41, 0
  buffer_load_dwordx4 v6, s[32:35], s43 offen lds
  s_add_u32 s42, s38, 126976
  s_mov_b32 m0, s42
  s_add_u32 s43, s41, 86016
  buffer_load_dwordx4 v6, s[32:35], s43 offen lds
  s_lshl_b32 s41, s40, 7
  s_add_u32 s41, s41, s36
  s_add_u32 s42, s38, 98304
  s_mov_b32 m0, s42
  s_add_u32 s43, s41, 0
  buffer_load_dwordx4 v3, s[28:31], s43 offen lds
  s_add_u32 s42, s38, 102400
  s_mov_b32 m0, s42
  s_add_u32 s43, s41, 28672
  buffer_load_dwordx4 v3, s[28:31], s43 offen lds
  s_waitcnt vmcnt(12)
  s_barrier
  s_add_u32 s40, s39, 0
  s_cmp_ge_u32 s40, 7
  s_cselect_b32 s41, 7, 0
  s_sub_u32 s40, s40, s41
  s_lshl_b32 s41, s40, 7
  s_add_u32 s41, s41, s36
  s_add_u32 s42, s38, 8192
  s_mov_b32 m0, s42
  s_add_u32 s43, s41, 57344
  buffer_load_dwordx4 v3, s[28:31], s43 offen lds
  s_add_u32 s42, s38, 12288
  s_mov_b32 m0, s42
  s_add_u32 s43, s41, 86016
  buffer_load_dwordx4 v3, s[28:31], s43 offen lds
  s_add_u32 s40, s39, 1
  s_cmp_ge_u32 s40, 7
  s_cselect_b32 s41, 7, 0
  s_sub_u32 s40, s40, s41
  s_lshl_b32 s41, s40, 7
  s_add_u32 s41, s41, s36
  s_add_u32 s42, s38, 24576
  s_mov_b32 m0, s42
  s_add_u32 s43, s41, 57344
  buffer_load_dwordx4 v3, s[28:31], s43 offen lds
  s_add_u32 s42, s38, 28672
  s_mov_b32 m0, s42
  s_add_u32 s43, s41, 86016
  buffer_load_dwordx4 v3, s[28:31], s43 offen lds
  s_add_u32 s40, s39, 2
  s_cmp_ge_u32 s40, 7
  s_cselect_b32 s41, 7, 0
  s_sub_u32 s40, s40, s41
  s_lshl_b32 s41, s40, 7
  s_add_u32 s41, s41, s36
  s_add_u32 s42, s38, 40960
  s_mov_b32 m0, s42
  s_add_u32 s43, s41, 57344
  buffer_load_dwordx4 v3, s[28:31], s43 offen lds
  s_add_u32 s42, s38, 45056
  s_mov_b32 m0, s42
  s_add_u32 s43, s41, 86016
  buffer_load_dwordx4 v3, s[28:31], s43 offen lds
  s_add_u32 s40, s39, 3
  s_cmp_ge_u32 s40, 7
  s_cselect_b32 s41, 7, 0
  s_sub_u32 s40, s40, s41
  s_lshl_b32 s41, s40, 7
  s_add_u32 s41, s41, s36
  s_add_u32 s42, s38, 57344
  s_mov_b32 m0, s42
  s_add_u32 s43, s41, 57344
  buffer_load_dwordx4 v3, s[28:31], s43 offen lds
  s_add_u32 s42, s38, 61440
  s_mov_b32 m0, s42
  s_add_u32 s43, s41, 86016
  buffer_load_dwordx4 v3, s[28:31], s43 offen lds
  s_waitcnt vmcnt(16)
  s_barrier
  s_mov_b64 exec, 0x7f
  buffer_load_dword v5, v15, s[8:11], s49 offen sc1
  s_mov_b64 exec, -1
  s_waitcnt vmcnt(13)
  s_barrier
  s_waitcnt vmcnt(9)
  s_barrier
L_LJOIN:
  s_waitcnt vmcnt(0)
  s_barrier
  s_mov_b32 s27, 0
L_WQPOLL:
  v_cmp_ne_u32 vcc, s63, v5
  s_add_u32 s27, s27, 1
  s_cmp_gt_u32 s27, 40000
  s_cbranch_scc1 L_WQOK
  s_and_b32 s40, vcc_lo, 0x7f
  s_cbranch_scc0 L_WQOK
  s_mov_b64 exec, 0x7f
  buffer_load_dword v5, v15, s[8:11], s49 offen sc1
  s_mov_b64 exec, -1
  s_waitcnt vmcnt(0)
  s_branch L_WQPOLL
L_WQOK:
  s_add_u32 s40, s39, 0
  s_cmp_ge_u32 s40, 7
  s_cselect_b32 s41, 7, 0
  s_sub_u32 s40, s40, s41
  s_lshl_b32 s41, s40, 12
  s_add_u32 s42, s38, 131072
  s_mov_b32 m0, s42
  s_add_u32 s43, s41, s45
  buffer_load_dwordx4 v9, s[8:11], s43 offen sc1 lds
  s_add_u32 s40, s39, 1
  s_cmp_ge_u32 s40, 7
  s_cselect_b32 s41, 7, 0
  s_sub_u32 s40, s40, s41
  s_lshl_b32 s41, s40, 12
  s_add_u32 s42, s38, 135168
  s_mov_b32 m0, s42
  s_add_u32 s43, s41, s45
  buffer_load_dwordx4 v9, s[8:11], s43 offen sc1 lds
  s_add_u32 s40, s39, 2
  s_cmp_ge_u32 s40, 7
  s_cselect_b32 s41, 7, 0
  s_sub_u32 s40, s40, s41
  s_lshl_b32 s41, s40, 12
  s_add_u32 s42, s38, 139264
  s_mov_b32 m0, s42
  s_add_u32 s43, s41, s45
  buffer_load_dwordx4 v9, s[8:11], s43 offen sc1 lds
  s_add_u32 s40, s39, 3
  s_cmp_ge_u32 s40, 7
  s_cselect_b32 s41, 7, 0
  s_sub_u32 s40, s40, s41
  s_lshl_b32 s41, s40, 12
  s_add_u32 s42, s38, 143360
  s_mov_b32 m0, s42
  s_add_u32 s43, s41, s45
  buffer_load_dwordx4 v9, s[8:11], s43 offen sc1 lds
  s_add_u32 s40, s39, 4
  s_cmp_ge_u32 s40, 7
  s_cselect_b32 s41, 7, 0
  s_sub_u32 s40, s40, s41
  s_lshl_b32 s41, s40, 12
  s_add_u32 s42, s38, 114688
  s_mov_b32 m0, s42
  s_add_u32 s43, s41, s45
  buffer_load_dwordx4 v9, s[8:11], s43 offen sc1 lds
  s_add_u32 s40, s39, 5
  s_cmp_ge_u32 s40, 7
  s_cselect_b32 s41, 7, 0
  s_sub_u32 s40, s40, s41
  s_lshl_b32 s41, s40, 12
  s_add_u32 s42, s38, 118784
  s_mov_b32 m0, s42
  s_add_u32 s43, s41, s45
  buffer_load_dwordx4 v9, s[8:11], s43 offen sc1 lds
  s_add_u32 s40, s39, 6
  s_cmp_ge_u32 s40, 7
  s_cselect_b32 s41, 7, 0
  s_sub_u32 s40, s40, s41
  s_lshl_b32 s41, s40, 12
  s_add_u32 s42, s38, 122880
  s_mov_b32 m0, s42
  s_add_u32 s43, s41, s45
  buffer_load_dwordx4 v9, s[8:11], s43 offen sc1 lds
  s_add_u32 s40, s39, 4
  s_cmp_ge_u32 s40, 7
  s_cselect_b32 s41, 7, 0
  s_sub_u32 s40, s40, s41
  s_lshl_b32 s41, s40, 7
  s_add_u32 s41, s41, s36
  s_add_u32 s42, s38, 73728
  s_mov_b32 m0, s42
  s_add_u32 s43, s41, 57344
  buffer_load_dwordx4 v3, s[28:31], s43 offen lds
  s_add_u32 s42, s38, 77824
  s_mov_b32 m0, s42
  s_add_u32 s43, s41, 86016
  buffer_load_dwordx4 v3, s[28:31], s43 offen lds
  s_add_u32 s40, s39, 5
  s_cmp_ge_u32 s40, 7
  s_cselect_b32 s41, 7, 0
  s_sub_u32 s40, s40, s41
  s_lshl_b32 s41, s40, 7
  s_add_u32 s41, s41, s36
  s_add_u32 s42, s38, 90112
  s_mov_b32 m0, s42
  s_add_u32 s43, s41, 57344
  buffer_load_dwordx4 v3, s[28:31], s43 offen lds
  s_add_u32 s42, s38, 94208
  s_mov_b32 m0, s42
  s_add_u32 s43, s41, 86016
  buffer_load_dwordx4 v3, s[28:31], s43 offen lds
  s_add_u32 s40, s39, 6
  s_cmp_ge_u32 s40, 7
  s_cselect_b32 s41, 7, 0
  s_sub_u32 s40, s40, s41
  s_lshl_b32 s41, s40, 7
  s_add_u32 s41, s41, s36
  s_add_u32 s42, s38, 106496
  s_mov_b32 m0, s42
  s_add_u32 s43, s41, 57344
  buffer_load_dwordx4 v3, s[28:31], s43 offen lds
  s_add_u32 s42, s38, 110592
  s_mov_b32 m0, s42
  s_add_u32 s43, s41, 86016
  buffer_load_dwordx4 v3, s[28:31], s43 offen lds
  s_waitcnt vmcnt(6)
  s_barrier
  s_waitcnt vmcnt(0)
  s_barrier
  s_branch L_LP1DONE
L_LRPK:
  s_add_u32 s42, s38, 114688
  s_mov_b32 m0, s42
  s_add_u32 s43, s59, 0
  buffer_load_dwordx4 v9, s[32:35], s43 offen lds
  s_add_u32 s42, s38, 118784
  s_mov_b32 m0, s42
  s_add_u32 s43, s59, 10752
  buffer_load_dwordx4 v9, s[32:35], s43 offen lds
  s_add_u32 s42, s38, 122880
  s_mov_b32 m0, s42
  s_add_u32 s43, s59, 21504
  buffer_load_dwordx4 v9, s[32:35], s43 offen lds
  s_add_u32 s42, s38, 126976
  s_mov_b32 m0, s42
  s_add_u32 s43, s59, 32256
  buffer_load_dwordx4 v9, s[32:35], s43 offen lds
  s_lshr_b32 s20, s2, 2
  s_and_b32 s21, s2, 3
  s_waitcnt lgkmcnt(0)
  s_add_u32 s63, s63, 0x9e3779b8
  v_bfe_u32 v16, v2, 5, 1
  v_bfe_u32 v17, v2, 4, 1
  v_and_b32 v18, 15, v2
  s_mul_i32 s27, s24, 28
  v_mul_u32_u24 v17, 27, v17
  v_add_u32 v17, s27, v17
  v_lshrrev_b32 v17, 6, v17
  v_mul_u32_u24 v16, 7, v16
  v_add_u32 v16, v16, v17
  v_lshl_add_u32 v16, v16, 4, v18
  v_lshlrev_b32 v249, 8, v16
  v_and_b32 v17, 31, v2
  v_add_u32 v17, 224, v17
  v_lshlrev_b32 v11, 8, v17
  v_mov_b32 v10, 1
  v_mov_b32 v12, s63
  v_and_b32 v14, 3, v2
  v_lshlrev_b32 v14, 7, v14
  v_and_b32 v15, 7, v2
  v_lshlrev_b32 v15, 9, v15
  s_lshl_b32 s49, s26, 7
  s_add_u32 s49, s49, 8589312
  s_lshr_b32 s27, s24, 2
  s_lshl_b32 s27, s27, 12
  s_add_u32 s49, s49, s27
  s_lshl_b32 s51, s22, 4
  s_add_u32 s51, s51, s25
  s_lshl_b32 s51, s51, 8
  s_add_u32 s51, s51, 8388608
  v_lshrrev_b32 v16, 4, v2
  v_and_b32 v17, 15, v2
  v_lshlrev_b32 v18, 2, v16
  v_xor_b32 v17, v17, v18
  v_mul_u32_u24 v16, 896, v16
  v_lshl_add_u32 v16, v17, 4, v16
  s_lshl_b32 s27, s21, 4
  v_add_u32 v17, s27, v17
  v_mov_b32 v18, 0x40000000
  v_cmp_le_u32 vcc, 56, v17
  s_nop 1
  v_cndmask_b32 v251, v16, v18, vcc
  s_mul_i32 s46, s26, 15360
  s_add_u32 s46, s46, 0
  v_and_b32 v16, 15, v2
  v_lshrrev_b32 v17, 2, v16
  v_bfe_u32 v18, v2, 4, 1
  v_lshlrev_b32 v18, 1, v18
  v_bfe_u32 v19, v16, 1, 1
  v_add_u32 v18, v18, v19
  v_lshrrev_b32 v21, 5, v2
  v_lshl_add_u32 v19, v21, 2, v17
  v_lshlrev_b32 v20, 8, v19
  v_lshl_add_u32 v20, v18, 4, v20
  v_and_b32 v19, 1, v16
  v_lshl_add_u32 v20, v19, 3, v20
  v_add_u32 v20, s46, v20
  s_add_u32 s27, s26, 0
  s_and_b32 s27, s27, 3
  v_xor_b32 v19, s27, v17
  v_lshl_add_u32 v252, v19, 6, v20
  s_add_u32 s27, s26, 1
  s_and_b32 s27, s27, 3
  v_xor_b32 v19, s27, v17
  v_lshl_add_u32 v253, v19, 6, v20
  s_add_u32 s27, s26, 2
  s_and_b32 s27, s27, 3
  v_xor_b32 v19, s27, v17
  v_lshl_add_u32 v254, v19, 6, v20
  s_add_u32 s27, s26, 3
  s_and_b32 s27, s27, 3
  v_xor_b32 v19, s27, v17
  v_lshl_add_u32 v255, v19, 6, v20
  v_lshlrev_b32 v240, 4, v2
  s_add_u32 s27, s26, 1
  s_and_b32 s27, s27, 3
  s_mul_i32 s27, s27, 12288
  s_add_u32 s27, s27, 0
  v_add_u32 v241, s27, v240
  s_add_u32 s27, s26, 2
  s_and_b32 s27, s27, 3
  s_mul_i32 s27, s27, 12288
  s_add_u32 s27, s27, 4096
  v_add_u32 v242, s27, v240
  s_add_u32 s27, s26, 3
  s_and_b32 s27, s27, 3
  s_mul_i32 s27, s27, 12288
  s_add_u32 s27, s27, 8192
  v_add_u32 v243, s27, v240
  s_mul_i32 s27, s26, 12288
  s_add_u32 s27, s27, 0
  v_add_u32 v244, s27, v240
  v_add_u32 v245, 4096, v240
  s_lshl_b32 s46, s20, 15
  s_lshl_b32 s27, s26, 13
  s_add_u32 s46, s46, s27
  s_add_u32 s46, s46, 6291456
  s_lshl_b32 s47, s20, 2
  s_add_u32 s47, s47, s26
  s_lshl_b32 s47, s47, 9
  s_add_u32 s47, s47, 8454144
  v_and_b32 v246, 31, v2
  v_mul_u32_u24 v246, 896, v246
  v_lshl_add_u32 v246, v21, 4, v246
  s_mul_i32 s48, s20, 28672
  s_lshl_b32 s27, s21, 8
  s_add_u32 s48, s48, s27
  s_lshl_b32 s27, s26, 6
  s_add_u32 s48, s48, s27
  v_mov_b32 v247, 155648
  v_mov_b32 v248, 0
  v_mov_b32 v176, 0
  v_mov_b32 v177, 0
  v_mov_b32 v178, 0
  v_mov_b32 v179, 0
  v_mov_b32 v180, 0
  v_mov_b32 v181, 0
  v_mov_b32 v182, 0
  v_mov_b32 v183, 0
  v_mov_b32 v184, 0
  v_mov_b32 v185, 0
  v_mov_b32 v186, 0
  v_mov_b32 v187, 0
  v_mov_b32 v188, 0
  v_mov_b32 v189, 0
  v_mov_b32 v190, 0
  v_mov_b32 v191, 0
  v_mov_b32 v192, 0
  v_mov_b32 v193, 0
  v_mov_b32 v194, 0
  v_mov_b32 v195, 0
  v_mov_b32 v196, 0
  v_mov_b32 v197, 0
  v_mov_b32 v198, 0
  v_mov_b32 v199, 0
  v_mov_b32 v200, 0
  v_mov_b32 v201, 0
  v_mov_b32 v202, 0
  v_mov_b32 v203, 0
  v_mov_b32 v204, 0
  v_mov_b32 v205, 0
  v_mov_b32 v206, 0
  v_mov_b32 v207, 0
  v_mov_b32 v208, 0
  v_mov_b32 v209, 0
  v_mov_b32 v210, 0
  v_mov_b32 v211, 0
  v_mov_b32 v212, 0
  v_mov_b32 v213, 0
  v_mov_b32 v214, 0
  v_mov_b32 v215, 0
  v_mov_b32 v216, 0
  v_mov_b32 v217, 0
  v_mov_b32 v218, 0
  v_mov_b32 v219, 0
  v_mov_b32 v220, 0
  v_mov_b32 v221, 0
  v_mov_b32 v222, 0
  v_mov_b32 v223, 0
  v_mov_b32 v224, 0
  v_mov_b32 v225, 0
  v_mov_b32 v226, 0
  v_mov_b32 v227, 0
  v_mov_b32 v228, 0
  v_mov_b32 v229, 0
  v_mov_b32 v230, 0
  v_mov_b32 v231, 0
  v_mov_b32 v232, 0
  v_mov_b32 v233, 0
  v_mov_b32 v234, 0
  v_mov_b32 v235, 0
  v_mov_b32 v236, 0
  v_mov_b32 v237, 0
  v_mov_b32 v238, 0
  v_mov_b32 v239, 0
  s_waitcnt vmcnt(0)
  s_barrier
  s_barrier
  s_add_u32 s40, s39, 0
  s_cmp_ge_u32 s40, 7
  s_cselect_b32 s41, 7, 0
  s_sub_u32 s40, s40, s41
  s_lshl_b32 s41, s40, 7
  s_add_u32 s41, s41, s36
  s_add_u32 s42, s38, 0
  s_mov_b32 m0, s42
  s_add_u32 s43, s41, 0
  buffer_load_dwordx4 v3, s[28:31], s43 offen lds
  s_add_u32 s42, s38, 4096
  s_mov_b32 m0, s42
  s_add_u32 s43, s41, 28672
  buffer_load_dwordx4 v3, s[28:31], s43 offen lds
  s_add_u32 s42, s38, 8192
  s_mov_b32 m0, s42
  s_add_u32 s43, s41, 57344
  buffer_load_dwordx4 v3, s[28:31], s43 offen lds
  s_add_u32 s42, s38, 12288
  s_mov_b32 m0, s42
  s_add_u32 s43, s41, 86016
  buffer_load_dwordx4 v3, s[28:31], s43 offen lds
  s_add_u32 s40, s39, 1
  s_cmp_ge_u32 s40, 7
  s_cselect_b32 s41, 7, 0
  s_sub_u32 s40, s40, s41
  s_lshl_b32 s41, s40, 7
  s_add_u32 s41, s41, s36
  s_add_u32 s42, s38, 16384
  s_mov_b32 m0, s42
  s_add_u32 s43, s41, 0
  buffer_load_dwordx4 v3, s[28:31], s43 offen lds
  s_add_u32 s42, s38, 20480
  s_mov_b32 m0, s42
  s_add_u32 s43, s41, 28672
  buffer_load_dwordx4 v3, s[28:31], s43 offen lds
  s_add_u32 s42, s38, 24576
  s_mov_b32 m0, s42
  s_add_u32 s43, s41, 57344
  buffer_load_dwordx4 v3, s[28:31], s43 offen lds
  s_add_u32 s42, s38, 28672
  s_mov_b32 m0, s42
  s_add_u32 s43, s41, 86016
  buffer_load_dwordx4 v3, s[28:31], s43 offen lds
  s_add_u32 s40, s39, 2
  s_cmp_ge_u32 s40, 7
  s_cselect_b32 s41, 7, 0
  s_sub_u32 s40, s40, s41
  s_lshl_b32 s41, s40, 7
  s_add_u32 s41, s41, s36
  s_add_u32 s42, s38, 32768
  s_mov_b32 m0, s42
  s_add_u32 s43, s41, 0
  buffer_load_dwordx4 v3, s[28:31], s43 offen lds
  s_add_u32 s42, s38, 36864
  s_mov_b32 m0, s42
  s_add_u32 s43, s41, 28672
  buffer_load_dwordx4 v3, s[28:31], s43 offen lds
  s_add_u32 s42, s38, 40960
  s_mov_b32 m0, s42
  s_add_u32 s43, s41, 57344
  buffer_load_dwordx4 v3, s[28:31], s43 offen lds
  s_add_u32 s42, s38, 45056
  s_mov_b32 m0, s42
  s_add_u32 s43, s41, 86016
  buffer_load_dwordx4 v3, s[28:31], s43 offen lds
  s_add_u32 s40, s39, 3
  s_cmp_ge_u32 s40, 7
  s_cselect_b32 s41, 7, 0
  s_sub_u32 s40, s40, s41
  s_lshl_b32 s41, s40, 7
  s_add_u32 s41, s41, s36
  s_add_u32 s42, s38, 49152
  s_mov_b32 m0, s42
  s_add_u32 s43, s41, 0
  buffer_load_dwordx4 v3, s[28:31], s43 offen lds
  s_add_u32 s42, s38, 53248
  s_mov_b32 m0, s42
  s_add_u32 s43, s41, 28672
  buffer_load_dwordx4 v3, s[28:31], s43 offen lds
  s_add_u32 s42, s38, 57344
  s_mov_b32 m0, s42
  s_add_u32 s43, s41, 57344
  buffer_load_dwordx4 v3, s[28:31], s43 offen lds
  s_add_u32 s42, s38, 61440
  s_mov_b32 m0, s42
  s_add_u32 s43, s41, 86016
  buffer_load_dwordx4 v3, s[28:31], s43 offen lds
  s_add_u32 s40, s39, 4
  s_cmp_ge_u32 s40, 7
  s_cselect_b32 s41, 7, 0
  s_sub_u32 s40, s40, s41
  s_lshl_b32 s41, s40, 7
  s_add_u32 s41, s41, s36
  s_add_u32 s42, s38, 65536
  s_mov_b32 m0, s42
  s_add_u32 s43, s41, 0
  buffer_load_dwordx4 v3, s[28:31], s43 offen lds
  s_add_u32 s42, s38, 69632
  s_mov_b32 m0, s42
  s_add_u32 s43, s41, 28672
  buffer_load_dwordx4 v3, s[28:31], s43 offen lds
  s_add_u32 s40, s39, 5
  s_cmp_ge_u32 s40, 7
  s_cselect_b32 s41, 7, 0
  s_sub_u32 s40, s40, s41
  s_lshl_b32 s41, s40, 7
  s_add_u32 s41, s41, s36
  s_add_u32 s42, s38, 81920
  s_mov_b32 m0, s42
  s_add_u32 s43, s41, 0
  buffer_load_dwordx4 v3, s[28:31], s43 offen lds
  s_add_u32 s42, s38, 86016
  s_mov_b32 m0, s42
  s_add_u32 s43, s41, 28672
  buffer_load_dwordx4 v3, s[28:31], s43 offen lds
  s_add_u32 s40, s39, 6
  s_cmp_ge_u32 s40, 7
  s_cselect_b32 s41, 7, 0
  s_sub_u32 s40, s40, s41
  s_lshl_b32 s41, s40, 7
  s_add_u32 s41, s41, s36
  s_add_u32 s42, s38, 98304
  s_mov_b32 m0, s42
  s_add_u32 s43, s41, 0
  buffer_load_dwordx4 v3, s[28:31], s43 offen lds
  s_add_u32 s42, s38, 102400
  s_mov_b32 m0, s42
  s_add_u32 s43, s41, 28672
  buffer_load_dwordx4 v3, s[28:31], s43 offen lds
  s_mov_b64 exec, 0x7f
  buffer_load_dword v5, v15, s[8:11], s49 offen sc1
  s_mov_b64 exec, -1
  s_branch L_LJOIN
L_LP1DONE:
  s_barrier
  s_cmp_lg_u32 s26, 3
  s_cbranch_scc1 L_NOPUBB
  s_mov_b64 exec, 1
  buffer_store_dword v12, v248, s[8:11], s51 offen offset:128 sc1
  s_mov_b64 exec, -1
L_NOPUBB:
  s_cmp_lg_u32 s26, 0
  s_cbranch_scc1 L_NOPOLLB
  s_sleep 16
  s_mov_b32 s27, 0
  s_mov_b32 s41, 8388736
L_POLLB:
  buffer_load_dword v4, v249, s[8:11], s41 offen sc1
  s_waitcnt vmcnt(0)
  v_cmp_ne_u32 vcc, s63, v4
  s_add_u32 s27, s27, 1
  s_cmp_gt_u32 s27, 40000
  s_cbranch_scc1 L_POUTB
  s_cmp_lg_u64 vcc, 0
  s_cbranch_scc0 L_POUTB
  s_sleep 8
  s_branch L_POLLB
L_POUTB:
  ds_write_b32 v247, v10 offset:8
  s_waitcnt lgkmcnt(0)
L_NOPOLLB:
  s_mov_b32 s28, s52
  s_mov_b32 s29, s53
  s_mov_b32 s30, 401408
  s_mov_b32 s31, 0x00020000
  s_mov_b32 s32, s54
  s_mov_b32 s33, s55
  s_mov_b32 s34, 1835008
  s_mov_b32 s35, 0x00020000
  s_mul_i32 s36, s26, 100352
  s_lshl_b32 s27, s21, 8
  s_add_u32 s36, s36, s27
  s_mul_i32 s38, s26, 15360
  s_add_u32 s38, s38, 0
  s_mov_b32 s27, 0
L_STGWAIT:
  s_sleep 8
  ds_read_b32 v250, v247 offset:8
  s_waitcnt lgkmcnt(0)
  v_readfirstlane_b32 s40, v250
  s_add_u32 s27, s27, 1
  s_cmp_gt_u32 s27, 320000
  s_cbranch_scc1 L_STGGO
  s_cmp_eq_u32 s40, 0
  s_cbranch_scc1 L_STGWAIT
L_STGGO:
  s_setprio 3
  s_sleep 32
  s_add_u32 s42, s38, 0
  s_mov_b32 m0, s42
  s_add_u32 s43, s36, 0
  buffer_load_dwordx4 v251, s[28:31], s43 offen lds
  s_sleep 3
  s_add_u32 s42, s38, 1024
  s_mov_b32 m0, s42
  s_add_u32 s43, s36, 3584
  buffer_load_dwordx4 v251, s[28:31], s43 offen lds
  s_sleep 3
  s_add_u32 s42, s38, 2048
  s_mov_b32 m0, s42
  s_add_u32 s43, s36, 7168
  buffer_load_dwordx4 v251, s[28:31], s43 offen lds
  s_sleep 3
  s_add_u32 s42, s38, 3072
  s_mov_b32 m0, s42
  s_add_u32 s43, s36, 10752
  buffer_load_dwordx4 v251, s[28:31], s43 offen lds
  s_sleep 3
  s_add_u32 s42, s38, 4096
  s_mov_b32 m0, s42
  s_add_u32 s43, s36, 14336
  buffer_load_dwordx4 v251, s[28:31], s43 offen lds
  s_sleep 3
  s_add_u32 s42, s38, 5120
  s_mov_b32 m0, s42
  s_add_u32 s43, s36, 17920
  buffer_load_dwordx4 v251, s[28:31], s43 offen lds
  s_sleep 3
  s_add_u32 s42, s38, 6144
  s_mov_b32 m0, s42
  s_add_u32 s43, s36, 21504
  buffer_load_dwordx4 v251, s[28:31], s43 offen lds
  s_sleep 3
  s_add_u32 s42, s38, 7168
  s_mov_b32 m0, s42
  s_add_u32 s43, s36, 25088
  buffer_load_dwordx4 v251, s[28:31], s43 offen lds
  s_sleep 3
  s_add_u32 s42, s38, 8192
  s_mov_b32 m0, s42
  s_add_u32 s43, s36, 28672
  buffer_load_dwordx4 v251, s[28:31], s43 offen lds
  s_sleep 3
  s_add_u32 s42, s38, 9216
  s_mov_b32 m0, s42
  s_add_u32 s43, s36, 32256
  buffer_load_dwordx4 v251, s[28:31], s43 offen lds
  s_sleep 3
  s_add_u32 s42, s38, 10240
  s_mov_b32 m0, s42
  s_add_u32 s43, s36, 35840
  buffer_load_dwordx4 v251, s[28:31], s43 offen lds
  s_sleep 3
  s_add_u32 s42, s38, 11264
  s_mov_b32 m0, s42
  s_add_u32 s43, s36, 39424
  buffer_load_dwordx4 v251, s[28:31], s43 offen lds
  s_sleep 3
  s_add_u32 s42, s38, 12288
  s_mov_b32 m0, s42
  s_add_u32 s43, s36, 43008
  buffer_load_dwordx4 v251, s[28:31], s43 offen lds
  s_sleep 3
  s_add_u32 s42, s38, 13312
  s_mov_b32 m0, s42
  s_add_u32 s43, s36, 46592
  buffer_load_dwordx4 v251, s[28:31], s43 offen lds
  s_sleep 3
  s_add_u32 s42, s38, 14336
  s_mov_b32 m0, s42
  s_add_u32 s43, s36, 50176
  buffer_load_dwordx4 v251, s[28:31], s43 offen lds
  s_sleep 3
  s_waitcnt vmcnt(0)
  ds_read_b64_tr_b16 v[16:17], v252 offset:0
  ds_read_b64_tr_b16 v[18:19], v252 offset:2048
  ds_read_b64_tr_b16 v[20:21], v253 offset:0
  ds_read_b64_tr_b16 v[22:23], v253 offset:2048
  ds_read_b64_tr_b16 v[24:25], v254 offset:0
  ds_read_b64_tr_b16 v[26:27], v254 offset:2048
  ds_read_b64_tr_b16 v[28:29], v255 offset:0
  ds_read_b64_tr_b16 v[30:31], v255 offset:2048
  s_waitcnt lgkmcnt(4)
  ds_read_b64_tr_b16 v[32:33], v252 offset:4096
  ds_read_b64_tr_b16 v[34:35], v252 offset:6144
  ds_read_b64_tr_b16 v[36:37], v253 offset:4096
  ds_read_b64_tr_b16 v[38:39], v253 offset:6144
  ds_read_b64_tr_b16 v[40:41], v254 offset:4096
  ds_read_b64_tr_b16 v[42:43], v254 offset:6144
  ds_read_b64_tr_b16 v[44:45], v255 offset:4096
  ds_read_b64_tr_b16 v[46:47], v255 offset:6144
  s_waitcnt lgkmcnt(4)
  ds_read_b64_tr_b16 v[48:49], v252 offset:7168
  ds_read_b64_tr_b16 v[50:51], v252 offset:9216
  ds_read_b64_tr_b16 v[52:53], v253 offset:7168
  ds_read_b64_tr_b16 v[54:55], v253 offset:9216
  ds_read_b64_tr_b16 v[56:57], v254 offset:7168
  ds_read_b64_tr_b16 v[58:59], v254 offset:9216
  ds_read_b64_tr_b16 v[60:61], v255 offset:7168
  ds_read_b64_tr_b16 v[62:63], v255 offset:9216
  s_waitcnt lgkmcnt(4)
  ds_read_b64_tr_b16 v[64:65], v252 offset:11264
  ds_read_b64_tr_b16 v[66:67], v252 offset:13312
  ds_read_b64_tr_b16 v[68:69], v253 offset:11264
  ds_read_b64_tr_b16 v[70:71], v253 offset:13312
  ds_read_b64_tr_b16 v[72:73], v254 offset:11264
  ds_read_b64_tr_b16 v[74:75], v254 offset:13312
  ds_read_b64_tr_b16 v[76:77], v255 offset:11264
  ds_read_b64_tr_b16 v[78:79], v255 offset:13312
  s_waitcnt lgkmcnt(4)
  s_waitcnt lgkmcnt(0)
  s_add_u32 s42, s38, 0
  s_mov_b32 m0, s42
  s_add_u32 s43, s36, 50176
  buffer_load_dwordx4 v251, s[28:31], s43 offen lds
  s_sleep 3
  s_add_u32 s42, s38, 1024
  s_mov_b32 m0, s42
  s_add_u32 s43, s36, 53760
  buffer_load_dwordx4 v251, s[28:31], s43 offen lds
  s_sleep 3
  s_add_u32 s42, s38, 2048
  s_mov_b32 m0, s42
  s_add_u32 s43, s36, 57344
  buffer_load_dwordx4 v251, s[28:31], s43 offen lds
  s_sleep 3
  s_add_u32 s42, s38, 3072
  s_mov_b32 m0, s42
  s_add_u32 s43, s36, 60928
  buffer_load_dwordx4 v251, s[28:31], s43 offen lds
  s_sleep 3
  s_add_u32 s42, s38, 4096
  s_mov_b32 m0, s42
  s_add_u32 s43, s36, 64512
  buffer_load_dwordx4 v251, s[28:31], s43 offen lds
  s_sleep 3
  s_add_u32 s42, s38, 5120
  s_mov_b32 m0, s42
  s_add_u32 s43, s36, 68096
  buffer_load_dwordx4 v251, s[28:31], s43 offen lds
  s_sleep 3
  s_add_u32 s42, s38, 6144
  s_mov_b32 m0, s42
  s_add_u32 s43, s36, 71680
  buffer_load_dwordx4 v251, s[28:31], s43 offen lds
  s_sleep 3
  s_add_u32 s42, s38, 7168
  s_mov_b32 m0, s42
  s_add_u32 s43, s36, 75264
  buffer_load_dwordx4 v251, s[28:31], s43 offen lds
  s_sleep 3
  s_add_u32 s42, s38, 8192
  s_mov_b32 m0, s42
  s_add_u32 s43, s36, 78848
  buffer_load_dwordx4 v251, s[28:31], s43 offen lds
  s_sleep 3
  s_add_u32 s42, s38, 9216
  s_mov_b32 m0, s42
  s_add_u32 s43, s36, 82432
  buffer_load_dwordx4 v251, s[28:31], s43 offen lds
  s_sleep 3
  s_add_u32 s42, s38, 10240
  s_mov_b32 m0, s42
  s_add_u32 s43, s36, 86016
  buffer_load_dwordx4 v251, s[28:31], s43 offen lds
  s_sleep 3
  s_add_u32 s42, s38, 11264
  s_mov_b32 m0, s42
  s_add_u32 s43, s36, 89600
  buffer_load_dwordx4 v251, s[28:31], s43 offen lds
  s_sleep 3
  s_add_u32 s42, s38, 12288
  s_mov_b32 m0, s42
  s_add_u32 s43, s36, 93184
  buffer_load_dwordx4 v251, s[28:31], s43 offen lds
  s_sleep 3
  s_add_u32 s42, s38, 13312
  s_mov_b32 m0, s42
  s_add_u32 s43, s36, 96768
  buffer_load_dwordx4 v251, s[28:31], s43 offen lds
  s_sleep 3
  s_add_u32 s42, s38, 14336
  s_mov_b32 m0, s42
  s_add_u32 s43, s36, 100352
  buffer_load_dwordx4 v251, s[28:31], s43 offen lds
  s_sleep 3
  s_waitcnt vmcnt(0)
  ds_read_b64_tr_b16 v[80:81], v252 offset:0
  ds_read_b64_tr_b16 v[82:83], v252 offset:2048
  ds_read_b64_tr_b16 v[84:85], v253 offset:0
  ds_read_b64_tr_b16 v[86:87], v253 offset:2048
  ds_read_b64_tr_b16 v[88:89], v254 offset:0
  ds_read_b64_tr_b16 v[90:91], v254 offset:2048
  ds_read_b64_tr_b16 v[92:93], v255 offset:0
  ds_read_b64_tr_b16 v[94:95], v255 offset:2048
  s_waitcnt lgkmcnt(4)
  ds_read_b64_tr_b16 v[96:97], v252 offset:4096
  ds_read_b64_tr_b16 v[98:99], v252 offset:6144
  ds_read_b64_tr_b16 v[100:101], v253 offset:4096
  ds_read_b64_tr_b16 v[102:103], v253 offset:6144
  ds_read_b64_tr_b16 v[104:105], v254 offset:4096
  ds_read_b64_tr_b16 v[106:107], v254 offset:6144
  ds_read_b64_tr_b16 v[108:109], v255 offset:4096
  ds_read_b64_tr_b16 v[110:111], v255 offset:6144
  s_waitcnt lgkmcnt(4)
  ds_read_b64_tr_b16 v[112:113], v252 offset:7168
  ds_read_b64_tr_b16 v[114:115], v252 offset:9216
  ds_read_b64_tr_b16 v[116:117], v253 offset:7168
  ds_read_b64_tr_b16 v[118:119], v253 offset:9216
  ds_read_b64_tr_b16 v[120:121], v254 offset:7168
  ds_read_b64_tr_b16 v[122:123], v254 offset:9216
  ds_read_b64_tr_b16 v[124:125], v255 offset:7168
  ds_read_b64_tr_b16 v[126:127], v255 offset:9216
  s_waitcnt lgkmcnt(4)
  ds_read_b64_tr_b16 v[128:129], v252 offset:11264
  ds_read_b64_tr_b16 v[130:131], v252 offset:13312
  ds_read_b64_tr_b16 v[132:133], v253 offset:11264
  ds_read_b64_tr_b16 v[134:135], v253 offset:13312
  ds_read_b64_tr_b16 v[136:137], v254 offset:11264
  ds_read_b64_tr_b16 v[138:139], v254 offset:13312
  ds_read_b64_tr_b16 v[140:141], v255 offset:11264
  ds_read_b64_tr_b16 v[142:143], v255 offset:13312
  s_waitcnt lgkmcnt(4)
  s_waitcnt lgkmcnt(0)
  s_setprio 3
  s_cmp_lg_u32 s2, 0
  s_cbranch_scc1 L_NOEP1
  s_cmp_lg_u32 s26, 1
  s_cbranch_scc1 L_NOEP1
  s_mov_b32 s27, 0
  s_mov_b32 s41, 8388736
L_POLLN:
  buffer_load_dword v4, v11, s[8:11], s41 offen sc1
  s_waitcnt vmcnt(0)
  v_cmp_ne_u32 vcc, s63, v4
  s_add_u32 s27, s27, 1
  s_cmp_gt_u32 s27, 40000
  s_cbranch_scc1 L_POUTN
  s_cmp_lg_u64 vcc, 0
  s_cbranch_scc0 L_POUTN
  s_sleep 8
  s_branch L_POLLN
L_POUTN:
L_NOEP1:
  s_mov_b32 s27, 0
L_C2POLL:
  buffer_load_dword v4, v14, s[8:11], s47 offen sc1
  s_waitcnt vmcnt(0)
  v_subrev_u32 v4, s63, v4
  v_cmp_lt_u32 vcc, 1, v4
  s_add_u32 s27, s27, 1
  s_cmp_gt_u32 s27, 40000
  s_cbranch_scc1 L_C2OUT
  s_cmp_lg_u64 vcc, 0
  s_cbranch_scc1 L_C2POLL
L_C2OUT:
  s_barrier
  s_mov_b64 exec, 15
  buffer_load_dword v4, v14, s[8:11], s47 offen sc1
  s_mov_b64 exec, -1
  ds_read_b32 v13, v247
  s_waitcnt lgkmcnt(0)
  v_readfirstlane_b32 s27, v13
  s_nop 3
  s_cmp_eq_u32 s27, 0
  s_cbranch_scc1 L_NOFB
  s_barrier
  s_barrier
L_NOFB:
  s_mov_b32 s27, 0
  s_mov_b32 s41, 15
  s_mov_b32 s43, 0
L_OPOLL:
  s_add_u32 s27, s27, 1
  s_cmp_gt_u32 s27, 40000
  s_cselect_b32 s42, 0, -1
  s_mov_b32 s49, 0
  s_waitcnt vmcnt(0)
  v_cmp_ne_u32 vcc, s63, v4
  s_nop 1
  s_and_b32 s50, vcc_lo, 15
  s_bitcmp0_b32 s43, 0
  s_cbranch_scc1 L_OC0
  v_max3_u32 v13, v144, v145, v146
  v_max3_u32 v15, v147, v148, v149
  v_max3_u32 v13, v13, v150, v151
  v_max_u32 v13, v13, v15
  v_cmp_eq_u32 vcc, -1, v13
  s_nop 1
  s_or_b32 s40, vcc_lo, vcc_hi
  s_and_b32 s40, s40, s42
  s_cbranch_scc1 L_OC0
  s_bitset0_b32 s41, 0
  s_bitset1_b32 s49, 0
L_OC0:
  s_bitcmp0_b32 s43, 1
  s_cbranch_scc1 L_OC1
  v_max3_u32 v13, v152, v153, v154
  v_max3_u32 v15, v155, v156, v157
  v_max3_u32 v13, v13, v158, v159
  v_max_u32 v13, v13, v15
  v_cmp_eq_u32 vcc, -1, v13
  s_nop 1
  s_or_b32 s40, vcc_lo, vcc_hi
  s_and_b32 s40, s40, s42
  s_cbranch_scc1 L_OC1
  s_bitset0_b32 s41, 1
  s_bitset1_b32 s49, 1
L_OC1:
  s_bitcmp0_b32 s43, 2
  s_cbranch_scc1 L_OC2
  v_max3_u32 v13, v160, v161, v162
  v_max3_u32 v15, v163, v164, v165
  v_max3_u32 v13, v13, v166, v167
  v_max_u32 v13, v13, v15
  v_cmp_eq_u32 vcc, -1, v13
  s_nop 1
  s_or_b32 s40, vcc_lo, vcc_hi
  s_and_b32 s40, s40, s42
  s_cbranch_scc1 L_OC2
  s_bitset0_b32 s41, 2
  s_bitset1_b32 s49, 2
L_OC2:
  s_bitcmp0_b32 s43, 3
  s_cbranch_scc1 L_OC3
  v_max3_u32 v13, v168, v169, v170
  v_max3_u32 v15, v171, v172, v173
  v_max3_u32 v13, v13, v174, v175
  v_max_u32 v13, v13, v15
  v_cmp_eq_u32 vcc, -1, v13
  s_nop 1
  s_or_b32 s40, vcc_lo, vcc_hi
  s_and_b32 s40, s40, s42
  s_cbranch_scc1 L_OC3
  s_bitset0_b32 s41, 3
  s_bitset1_b32 s49, 3
L_OC3:
  s_orn2_b32 s40, s50, s42
  s_and_b32 s43, s40, s41
  s_bitcmp0_b32 s43, 0
  s_cbranch_scc1 L_OI0
  buffer_load_dwordx4 v[144:147], v240, s[8:11], s46 offen offset:0 sc1
  buffer_load_dwordx4 v[148:151], v240, s[8:11], s46 offen offset:1024 sc1
L_OI0:
  s_bitcmp0_b32 s43, 1
  s_cbranch_scc1 L_OI1
  buffer_load_dwordx4 v[152:155], v240, s[8:11], s46 offen offset:2048 sc1
  buffer_load_dwordx4 v[156:159], v240, s[8:11], s46 offen offset:3072 sc1
L_OI1:
  s_bitcmp0_b32 s43, 2
  s_cbranch_scc1 L_OI2
  buffer_load_dwordx4 v[160:163], v245, s[8:11], s46 offen offset:0 sc1
  buffer_load_dwordx4 v[164:167], v245, s[8:11], s46 offen offset:1024 sc1
L_OI2:
  s_bitcmp0_b32 s43, 3
  s_cbranch_scc1 L_OI3
  buffer_load_dwordx4 v[168:171], v245, s[8:11], s46 offen offset:2048 sc1
  buffer_load_dwordx4 v[172:175], v245, s[8:11], s46 offen offset:3072 sc1
L_OI3:
  s_cmp_eq_u32 s43, s41
  s_cbranch_scc1 L_ONOPOLL
  s_mov_b64 exec, 15
  buffer_load_dword v4, v14, s[8:11], s47 offen sc1
  s_mov_b64 exec, -1
L_ONOPOLL:
  s_bitcmp0_b32 s49, 0
  s_cbranch_scc1 L_OM0
  v_mfma_f32_32x32x16_bf16 v[176:191], v[16:19], v[144:147], v[176:191]
  v_mfma_f32_32x32x16_bf16 v[192:207], v[20:23], v[144:147], v[192:207]
  v_mfma_f32_32x32x16_bf16 v[208:223], v[24:27], v[144:147], v[208:223]
  v_mfma_f32_32x32x16_bf16 v[224:239], v[28:31], v[144:147], v[224:239]
  v_mfma_f32_32x32x16_bf16 v[176:191], v[32:35], v[148:151], v[176:191]
  v_mfma_f32_32x32x16_bf16 v[192:207], v[36:39], v[148:151], v[192:207]
  v_mfma_f32_32x32x16_bf16 v[208:223], v[40:43], v[148:151], v[208:223]
  v_mfma_f32_32x32x16_bf16 v[224:239], v[44:47], v[148:151], v[224:239]
L_OM0:
  s_bitcmp0_b32 s49, 1
  s_cbranch_scc1 L_OM1
  v_mfma_f32_32x32x16_bf16 v[176:191], v[48:51], v[152:155], v[176:191]
  v_mfma_f32_32x32x16_bf16 v[192:207], v[52:55], v[152:155], v[192:207]
  v_mfma_f32_32x32x16_bf16 v[208:223], v[56:59], v[152:155], v[208:223]
  v_mfma_f32_32x32x16_bf16 v[224:239], v[60:63], v[152:155], v[224:239]
  v_mfma_f32_32x32x16_bf16 v[176:191], v[64:67], v[156:159], v[176:191]
  v_mfma_f32_32x32x16_bf16 v[192:207], v[68:71], v[156:159], v[192:207]
  v_mfma_f32_32x32x16_bf16 v[208:223], v[72:75], v[156:159], v[208:223]
  v_mfma_f32_32x32x16_bf16 v[224:239], v[76:79], v[156:159], v[224:239]
L_OM1:
  s_bitcmp0_b32 s49, 2
  s_cbranch_scc1 L_OM2
  v_mfma_f32_32x32x16_bf16 v[176:191], v[80:83], v[160:163], v[176:191]
  v_mfma_f32_32x32x16_bf16 v[192:207], v[84:87], v[160:163], v[192:207]
  v_mfma_f32_32x32x16_bf16 v[208:223], v[88:91], v[160:163], v[208:223]
  v_mfma_f32_32x32x16_bf16 v[224:239], v[92:95], v[160:163], v[224:239]
  v_mfma_f32_32x32x16_bf16 v[176:191], v[96:99], v[164:167], v[176:191]
  v_mfma_f32_32x32x16_bf16 v[192:207], v[100:103], v[164:167], v[192:207]
  v_mfma_f32_32x32x16_bf16 v[208:223], v[104:107], v[164:167], v[208:223]
  v_mfma_f32_32x32x16_bf16 v[224:239], v[108:111], v[164:167], v[224:239]
L_OM2:
  s_bitcmp0_b32 s49, 3
  s_cbranch_scc1 L_OM3
  v_mfma_f32_32x32x16_bf16 v[176:191], v[112:115], v[168:171], v[176:191]
  v_mfma_f32_32x32x16_bf16 v[192:207], v[116:119], v[168:171], v[192:207]
  v_mfma_f32_32x32x16_bf16 v[208:223], v[120:123], v[168:171], v[208:223]
  v_mfma_f32_32x32x16_bf16 v[224:239], v[124:127], v[168:171], v[224:239]
  v_mfma_f32_32x32x16_bf16 v[176:191], v[128:131], v[172:175], v[176:191]
  v_mfma_f32_32x32x16_bf16 v[192:207], v[132:135], v[172:175], v[192:207]
  v_mfma_f32_32x32x16_bf16 v[208:223], v[136:139], v[172:175], v[208:223]
  v_mfma_f32_32x32x16_bf16 v[224:239], v[140:143], v[172:175], v[224:239]
L_OM3:
  s_cmp_lg_u32 s41, 0
  s_cbranch_scc1 L_OPOLL
  s_nop 7
  s_nop 3
  ds_write_b128 v241, v[192:195] offset:0
  ds_write_b128 v241, v[196:199] offset:1024
  ds_write_b128 v241, v[200:203] offset:2048
  ds_write_b128 v241, v[204:207] offset:3072
  ds_write_b128 v242, v[208:211] offset:0
  ds_write_b128 v242, v[212:215] offset:1024
  ds_write_b128 v242, v[216:219] offset:2048
  ds_write_b128 v242, v[220:223] offset:3072
  ds_write_b128 v243, v[224:227] offset:0
  ds_write_b128 v243, v[228:231] offset:1024
  ds_write_b128 v243, v[232:235] offset:2048
  ds_write_b128 v243, v[236:239] offset:3072
  s_waitcnt lgkmcnt(0)
  s_barrier
  s_cmp_lg_u32 s2, 0
  s_cbranch_scc1 L_NOEP2
  s_cmp_lg_u32 s26, 1
  s_cbranch_scc1 L_NOEP2
  v_mov_b32 v4, s63
  s_mov_b32 s27, 8586240
  s_mov_b64 exec, 1
  buffer_store_dword v4, v248, s[8:11], s27 offen sc1
  s_mov_b64 exec, -1
L_NOEP2:
  ds_read_b128 v[16:19], v244 offset:0
  ds_read_b128 v[20:23], v244 offset:1024
  ds_read_b128 v[24:27], v244 offset:2048
  ds_read_b128 v[28:31], v244 offset:3072
  ds_read_b128 v[32:35], v244 offset:4096
  ds_read_b128 v[36:39], v244 offset:5120
  ds_read_b128 v[40:43], v244 offset:6144
  ds_read_b128 v[44:47], v244 offset:7168
  ds_read_b128 v[48:51], v244 offset:8192
  ds_read_b128 v[52:55], v244 offset:9216
  ds_read_b128 v[56:59], v244 offset:10240
  ds_read_b128 v[60:63], v244 offset:11264
  s_waitcnt lgkmcnt(11)
  v_pk_add_f32 v[176:177], v[176:177], v[16:17]
  v_pk_add_f32 v[178:179], v[178:179], v[18:19]
  s_waitcnt lgkmcnt(10)
  v_pk_add_f32 v[180:181], v[180:181], v[20:21]
  v_pk_add_f32 v[182:183], v[182:183], v[22:23]
  s_waitcnt lgkmcnt(9)
  v_pk_add_f32 v[184:185], v[184:185], v[24:25]
  v_pk_add_f32 v[186:187], v[186:187], v[26:27]
  s_waitcnt lgkmcnt(8)
  v_pk_add_f32 v[188:189], v[188:189], v[28:29]
  v_pk_add_f32 v[190:191], v[190:191], v[30:31]
  s_waitcnt lgkmcnt(7)
  v_pk_add_f32 v[176:177], v[176:177], v[32:33]
  v_pk_add_f32 v[178:179], v[178:179], v[34:35]
  s_waitcnt lgkmcnt(6)
  v_pk_add_f32 v[180:181], v[180:181], v[36:37]
  v_pk_add_f32 v[182:183], v[182:183], v[38:39]
  s_waitcnt lgkmcnt(5)
  v_pk_add_f32 v[184:185], v[184:185], v[40:41]
  v_pk_add_f32 v[186:187], v[186:187], v[42:43]
  s_waitcnt lgkmcnt(4)
  v_pk_add_f32 v[188:189], v[188:189], v[44:45]
  v_pk_add_f32 v[190:191], v[190:191], v[46:47]
  s_waitcnt lgkmcnt(3)
  v_pk_add_f32 v[176:177], v[176:177], v[48:49]
  v_pk_add_f32 v[178:179], v[178:179], v[50:51]
  s_waitcnt lgkmcnt(2)
  v_pk_add_f32 v[180:181], v[180:181], v[52:53]
  v_pk_add_f32 v[182:183], v[182:183], v[54:55]
  s_waitcnt lgkmcnt(1)
  v_pk_add_f32 v[184:185], v[184:185], v[56:57]
  v_pk_add_f32 v[186:187], v[186:187], v[58:59]
  s_waitcnt lgkmcnt(0)
  v_pk_add_f32 v[188:189], v[188:189], v[60:61]
  v_pk_add_f32 v[190:191], v[190:191], v[62:63]
  v_cvt_pk_bf16_f32 v144, v176, v177
  v_cvt_pk_bf16_f32 v145, v178, v179
  v_cvt_pk_bf16_f32 v146, v180, v181
  v_cvt_pk_bf16_f32 v147, v182, v183
  v_cvt_pk_bf16_f32 v148, v184, v185
  v_cvt_pk_bf16_f32 v149, v186, v187
  v_cvt_pk_bf16_f32 v150, v188, v189
  v_cvt_pk_bf16_f32 v151, v190, v191
  s_lshl_b32 s27, s21, 2
  s_add_u32 s27, s27, s26
  s_cmp_ge_u32 s27, 14
  s_cbranch_scc1 L_END
  v_permlane32_swap_b32 v144, v146
  v_permlane32_swap_b32 v145, v147
  v_permlane32_swap_b32 v148, v150
  v_permlane32_swap_b32 v149, v151
  buffer_store_dwordx4 v[144:147], v246, s[32:35], s48 offen offset:0
  buffer_store_dwordx4 v[148:151], v246, s[32:35], s48 offen offset:32
  s_branch L_END
L_CWAVE:
  s_lshl_b32 s26, s25, 2
  s_add_u32 s26, s26, s3
  s_lshl_b32 s35, s26, 4
  s_add_u32 s35, s35, s24
  s_lshl_b32 s35, s35, 11
  s_add_u32 s35, s35, 6291456
  s_lshl_b32 s33, s26, 4
  s_add_u32 s33, s33, s24
  s_lshl_b32 s33, s33, 7
  s_add_u32 s33, s33, 8454144
  s_waitcnt lgkmcnt(0)
  s_add_u32 s56, s6, 8586240
  s_addc_u32 s57, s7, 0
  s_load_dword s63, s[56:57], 0
  s_mov_b32 s8, s6
  s_mov_b32 s9, s7
  s_mov_b32 s10, 8781824
  s_mov_b32 s11, 0x00020000
  v_mov_b32 v5, 155648
  v_mov_b32 v64, 0
  v_mov_b32 v65, 0
  v_mov_b32 v66, 0
  v_mov_b32 v67, 0
  ds_write_b128 v5, v[64:67]
  s_and_b32 s27, s3, 1
  s_lshr_b32 s28, s3, 1
  s_lshl_b32 s26, s22, 1
  s_add_u32 s26, s26, s27
  s_lshr_b32 s60, s25, 2
  s_lshl_b32 s60, s60, 4
  s_and_b32 s29, s25, 3
  s_lshl_b32 s29, s29, 1
  s_add_u32 s60, s60, s29
  s_add_u32 s60, s60, s28
  s_lshl_b32 s60, s60, 12
  s_add_u32 s60, s60, 2097152
  s_add_u32 s61, s60, 32768
  s_lshl_b32 s62, s26, 4
  s_add_u32 s62, s62, s25
  s_lshl_b32 s62, s62, 1
  s_add_u32 s62, s62, s28
  s_lshl_b32 s62, s62, 7
  s_add_u32 s62, s62, 8650752
  v_and_b32 v3, 31, v2
  v_lshrrev_b32 v4, 5, v2
  v_bfe_u32 v5, v3, 1, 3
  s_lshl_b32 s29, s28, 12
  s_lshl_b32 s40, s3, 12
  v_add_u32 v6, 0, v4
  v_xor_b32 v6, v6, v5
  v_lshlrev_b32 v6, 4, v6
  v_lshl_add_u32 v6, v3, 7, v6
  v_add_u32 v8, s29, v6
  v_add_u32 v132, 0x10000, v8
  v_add_u32 v52, s40, v6
  v_add_u32 v56, 0x10000, v52
  v_add_u32 v6, 2, v4
  v_xor_b32 v6, v6, v5
  v_lshlrev_b32 v6, 4, v6
  v_lshl_add_u32 v6, v3, 7, v6
  v_add_u32 v9, s29, v6
  v_add_u32 v133, 0x10000, v9
  v_add_u32 v53, s40, v6
  v_add_u32 v57, 0x10000, v53
  v_add_u32 v6, 4, v4
  v_xor_b32 v6, v6, v5
  v_lshlrev_b32 v6, 4, v6
  v_lshl_add_u32 v6, v3, 7, v6
  v_add_u32 v10, s29, v6
  v_add_u32 v134, 0x10000, v10
  v_add_u32 v54, s40, v6
  v_add_u32 v58, 0x10000, v54
  v_add_u32 v6, 6, v4
  v_xor_b32 v6, v6, v5
  v_lshlrev_b32 v6, 4, v6
  v_lshl_add_u32 v6, v3, 7, v6
  v_add_u32 v11, s29, v6
  v_add_u32 v135, 0x10000, v11
  v_add_u32 v55, s40, v6
  v_add_u32 v59, 0x10000, v55
  v_and_b32 v5, 15, v2
  v_lshrrev_b32 v6, 2, v5
  v_bfe_u32 v7, v2, 4, 1
  v_lshlrev_b32 v7, 1, v7
  v_bfe_u32 v13, v5, 1, 1
  v_add_u32 v7, v7, v13
  s_lshl_b32 s29, s27, 2
  v_add_u32 v7, s29, v7
  v_bfe_u32 v13, v5, 3, 1
  v_lshlrev_b32 v13, 2, v13
  v_xor_b32 v7, v7, v13
  v_lshl_add_u32 v6, v4, 3, v6
  v_lshlrev_b32 v12, 7, v6
  v_lshl_add_u32 v12, v7, 4, v12
  v_and_b32 v13, 1, v5
  v_lshl_add_u32 v12, v13, 3, v12
  v_add_u32 v12, 114688, v12
  v_bfe_u32 v7, v2, 4, 1
  v_lshl_add_u32 v7, v7, 1, v13
  v_bfe_u32 v13, v5, 1, 1
  v_cmp_eq_u32 vcc, 3, v7
  v_lshl_add_u32 v7, v7, 1, v13
  v_add_u32 v13, 1, v7
  v_lshlrev_b32 v136, 10, v6
  s_mul_i32 s29, s3, 224
  s_add_u32 s29, s29, 114688
  v_add_u32 v136, s29, v136
  v_cndmask_b32 v7, v7, 6, vcc
  v_cndmask_b32 v13, v13, 0, vcc
  v_lshl_add_u32 v141, v7, 3, v136
  v_lshl_add_u32 v142, v13, 3, v136
  v_mov_b32 v137, 0
  v_lshlrev_b32 v139, 4, v2
  v_add_u32 v136, 114688, v139
  v_bfe_u32 v5, v2, 4, 1
  v_bfe_u32 v6, v2, 3, 1
  s_mul_i32 s29, s24, 28
  v_mul_u32_u24 v6, 27, v6
  v_add_u32 v6, s29, v6
  v_lshrrev_b32 v6, 5, v6
  v_mul_u32_u24 v5, 14, v5
  v_add_u32 v5, v5, v6
  v_cmp_gt_u32 vcc, 32, v2
  v_and_b32 v6, 7, v2
  s_lshl_b32 s29, s3, 3
  v_add_u32 v6, s29, v6
  v_cndmask_b32 v6, 0, v6, vcc
  v_lshl_add_u32 v5, v5, 5, v6
  v_lshlrev_b32 v140, 7, v5
  s_waitcnt lgkmcnt(0)
  s_add_u32 s63, s63, 0x9e3779b8
  v_mov_b32 v138, s63
  s_mov_b32 s41, 8650752
  s_mov_b32 s46, -1
  s_mov_b32 s47, 0xffff
  s_cmp_ge_u32 s26, 28
  s_cbranch_scc1 L_RPK
  s_cmp_ge_u32 s26, 14
  s_cbranch_scc1 L_VPART
  s_mov_b32 s42, 0x3f803f80
  s_mov_b32 s43, 0x3f80
  s_lshl_b32 s27, s26, 2
  v_add_u32 v5, 0, v4
  v_add_u32 v5, s27, v5
  v_mul_u32_u24 v6, 37, v5
  v_lshrrev_b32 v6, 8, v6
  v_mul_u32_u24 v7, 7, v6
  v_sub_u32 v5, v5, v7
  v_cmp_eq_u32 s[48:49], 3, v5
  v_lshrrev_b32 v7, 2, v5
  v_lshl_add_u32 v6, v6, 1, v7
  v_and_b32 v5, 3, v5
  v_lshlrev_b32 v128, 18, v6
  v_lshl_add_u32 v128, v5, 9, v128
  v_lshl_add_u32 v128, v3, 4, v128
  v_add_u32 v130, 0x40000, v128
  v_add_u32 v5, 2, v4
  v_add_u32 v5, s27, v5
  v_mul_u32_u24 v6, 37, v5
  v_lshrrev_b32 v6, 8, v6
  v_mul_u32_u24 v7, 7, v6
  v_sub_u32 v5, v5, v7
  v_cmp_eq_u32 s[50:51], 3, v5
  v_lshrrev_b32 v7, 2, v5
  v_lshl_add_u32 v6, v6, 1, v7
  v_and_b32 v5, 3, v5
  v_lshlrev_b32 v129, 18, v6
  v_lshl_add_u32 v129, v5, 9, v129
  v_lshl_add_u32 v129, v3, 4, v129
  v_add_u32 v131, 0x40000, v129
  s_nop 0
  s_barrier
  ds_read_b64_tr_b16 v[144:145], v12 offset:0
  ds_read_b64_tr_b16 v[146:147], v12 offset:512
  ds_read_b128 v[64:67], v8 offset:0
  ds_read_b64_tr_b16 v[148:149], v12 offset:2048
  ds_read_b64_tr_b16 v[150:151], v12 offset:2560
  ds_read_b128 v[68:71], v9 offset:0
  ds_read_b64_tr_b16 v[152:153], v12 offset:4096
  ds_read_b64_tr_b16 v[154:155], v12 offset:4608
  ds_read_b128 v[72:75], v10 offset:0
  ds_read_b64_tr_b16 v[156:157], v12 offset:6144
  ds_read_b64_tr_b16 v[158:159], v12 offset:6656
  ds_read_b128 v[76:79], v11 offset:0
  s_waitcnt lgkmcnt(9)
  v_mfma_f32_32x32x16_bf16 v[16:31], v[144:147], v[64:67], 0
  s_waitcnt lgkmcnt(6)
  v_mfma_f32_32x32x16_bf16 v[16:31], v[148:151], v[68:71], v[16:31]
  s_waitcnt lgkmcnt(3)
  v_mfma_f32_32x32x16_bf16 v[16:31], v[152:155], v[72:75], v[16:31]
  s_waitcnt lgkmcnt(0)
  v_mfma_f32_32x32x16_bf16 v[16:31], v[156:159], v[76:79], v[16:31]
  s_barrier
  ds_read_b64_tr_b16 v[160:161], v12 offset:8192
  ds_read_b64_tr_b16 v[162:163], v12 offset:8704
  ds_read_b128 v[64:67], v8 offset:16384
  ds_read_b64_tr_b16 v[164:165], v12 offset:10240
  ds_read_b64_tr_b16 v[166:167], v12 offset:10752
  ds_read_b128 v[68:71], v9 offset:16384
  ds_read_b64_tr_b16 v[168:169], v12 offset:12288
  ds_read_b64_tr_b16 v[170:171], v12 offset:12800
  ds_read_b128 v[72:75], v10 offset:16384
  ds_read_b64_tr_b16 v[172:173], v12 offset:14336
  ds_read_b64_tr_b16 v[174:175], v12 offset:14848
  ds_read_b128 v[76:79], v11 offset:16384
  s_waitcnt lgkmcnt(9)
  v_mfma_f32_32x32x16_bf16 v[16:31], v[160:163], v[64:67], v[16:31]
  s_waitcnt lgkmcnt(6)
  v_mfma_f32_32x32x16_bf16 v[16:31], v[164:167], v[68:71], v[16:31]
  s_waitcnt lgkmcnt(3)
  v_mfma_f32_32x32x16_bf16 v[16:31], v[168:171], v[72:75], v[16:31]
  s_waitcnt lgkmcnt(0)
  v_mfma_f32_32x32x16_bf16 v[16:31], v[172:175], v[76:79], v[16:31]
  s_barrier
  ds_read_b64_tr_b16 v[176:177], v12 offset:16384
  ds_read_b64_tr_b16 v[178:179], v12 offset:16896
  ds_read_b128 v[64:67], v8 offset:32768
  ds_read_b64_tr_b16 v[180:181], v12 offset:18432
  ds_read_b64_tr_b16 v[182:183], v12 offset:18944
  ds_read_b128 v[68:71], v9 offset:32768
  ds_read_b64_tr_b16 v[184:185], v12 offset:20480
  ds_read_b64_tr_b16 v[186:187], v12 offset:20992
  ds_read_b128 v[72:75], v10 offset:32768
  ds_read_b64_tr_b16 v[188:189], v12 offset:22528
  ds_read_b64_tr_b16 v[190:191], v12 offset:23040
  ds_read_b128 v[76:79], v11 offset:32768
  s_waitcnt lgkmcnt(9)
  v_mfma_f32_32x32x16_bf16 v[16:31], v[176:179], v[64:67], v[16:31]
  s_waitcnt lgkmcnt(6)
  v_mfma_f32_32x32x16_bf16 v[16:31], v[180:183], v[68:71], v[16:31]
  s_waitcnt lgkmcnt(3)
  v_mfma_f32_32x32x16_bf16 v[16:31], v[184:187], v[72:75], v[16:31]
  s_waitcnt lgkmcnt(0)
  v_mfma_f32_32x32x16_bf16 v[16:31], v[188:191], v[76:79], v[16:31]
  v_mov_b32 v96, -1
  v_mov_b32 v97, -1
  v_mov_b32 v98, -1
  v_mov_b32 v99, -1
  buffer_store_dwordx4 v[96:99], v139, s[8:11], s35 offen offset:0 sc1
  buffer_store_dwordx4 v[96:99], v139, s[8:11], s35 offen offset:1024 sc1
  s_barrier
  ds_read_b64_tr_b16 v[192:193], v12 offset:24576
  ds_read_b64_tr_b16 v[194:195], v12 offset:25088
  ds_read_b128 v[64:67], v8 offset:49152
  ds_read_b64_tr_b16 v[196:197], v12 offset:26624
  ds_read_b64_tr_b16 v[198:199], v12 offset:27136
  ds_read_b128 v[68:71], v9 offset:49152
  ds_read_b64_tr_b16 v[200:201], v12 offset:28672
  ds_read_b64_tr_b16 v[202:203], v12 offset:29184
  ds_read_b128 v[72:75], v10 offset:49152
  ds_read_b64_tr_b16 v[204:205], v12 offset:30720
  ds_read_b64_tr_b16 v[206:207], v12 offset:31232
  ds_read_b128 v[76:79], v11 offset:49152
  s_waitcnt lgkmcnt(9)
  v_mfma_f32_32x32x16_bf16 v[16:31], v[192:195], v[64:67], v[16:31]
  s_waitcnt lgkmcnt(6)
  v_mfma_f32_32x32x16_bf16 v[16:31], v[196:199], v[68:71], v[16:31]
  s_waitcnt lgkmcnt(3)
  v_mfma_f32_32x32x16_bf16 v[16:31], v[200:203], v[72:75], v[16:31]
  s_waitcnt lgkmcnt(0)
  v_mfma_f32_32x32x16_bf16 v[16:31], v[204:207], v[76:79], v[16:31]
  s_barrier
  ds_read_b64_tr_b16 v[208:209], v12 offset:32768
  ds_read_b64_tr_b16 v[210:211], v12 offset:33280
  ds_read_b128 v[64:67], v132 offset:0
  ds_read_b64_tr_b16 v[212:213], v12 offset:34816
  ds_read_b64_tr_b16 v[214:215], v12 offset:35328
  ds_read_b128 v[68:71], v133 offset:0
  ds_read_b64_tr_b16 v[216:217], v12 offset:36864
  ds_read_b64_tr_b16 v[218:219], v12 offset:37376
  ds_read_b128 v[72:75], v134 offset:0
  ds_read_b64_tr_b16 v[220:221], v12 offset:38912
  ds_read_b64_tr_b16 v[222:223], v12 offset:39424
  ds_read_b128 v[76:79], v135 offset:0
  s_waitcnt lgkmcnt(9)
  v_mfma_f32_32x32x16_bf16 v[16:31], v[208:211], v[64:67], v[16:31]
  s_waitcnt lgkmcnt(6)
  v_mfma_f32_32x32x16_bf16 v[16:31], v[212:215], v[68:71], v[16:31]
  s_waitcnt lgkmcnt(3)
  v_mfma_f32_32x32x16_bf16 v[16:31], v[216:219], v[72:75], v[16:31]
  s_waitcnt lgkmcnt(0)
  v_mfma_f32_32x32x16_bf16 v[16:31], v[220:223], v[76:79], v[16:31]
  s_barrier
  ds_read_b64_tr_b16 v[224:225], v12 offset:0
  ds_read_b64_tr_b16 v[226:227], v12 offset:512
  ds_read_b128 v[64:67], v132 offset:16384
  ds_read_b64_tr_b16 v[228:229], v12 offset:2048
  ds_read_b64_tr_b16 v[230:231], v12 offset:2560
  ds_read_b128 v[68:71], v133 offset:16384
  ds_read_b64_tr_b16 v[232:233], v12 offset:4096
  ds_read_b64_tr_b16 v[234:235], v12 offset:4608
  ds_read_b128 v[72:75], v134 offset:16384
  ds_read_b64_tr_b16 v[236:237], v12 offset:6144
  ds_read_b64_tr_b16 v[238:239], v12 offset:6656
  ds_read_b128 v[76:79], v135 offset:16384
  s_waitcnt lgkmcnt(9)
  v_mfma_f32_32x32x16_bf16 v[16:31], v[224:227], v[64:67], v[16:31]
  s_waitcnt lgkmcnt(6)
  v_mfma_f32_32x32x16_bf16 v[16:31], v[228:231], v[68:71], v[16:31]
  s_waitcnt lgkmcnt(3)
  v_mfma_f32_32x32x16_bf16 v[16:31], v[232:235], v[72:75], v[16:31]
  s_waitcnt lgkmcnt(0)
  v_mfma_f32_32x32x16_bf16 v[16:31], v[236:239], v[76:79], v[16:31]
  s_barrier
  ds_read_b64_tr_b16 v[240:241], v12 offset:8192
  ds_read_b64_tr_b16 v[242:243], v12 offset:8704
  ds_read_b128 v[64:67], v132 offset:32768
  ds_read_b64_tr_b16 v[244:245], v12 offset:10240
  ds_read_b64_tr_b16 v[246:247], v12 offset:10752
  ds_read_b128 v[68:71], v133 offset:32768
  ds_read_b64_tr_b16 v[248:249], v12 offset:12288
  ds_read_b64_tr_b16 v[250:251], v12 offset:12800
  ds_read_b128 v[72:75], v134 offset:32768
  ds_read_b64_tr_b16 v[252:253], v12 offset:14336
  ds_read_b64_tr_b16 v[254:255], v12 offset:14848
  ds_read_b128 v[76:79], v135 offset:32768
  s_waitcnt lgkmcnt(9)
  v_mfma_f32_32x32x16_bf16 v[16:31], v[240:243], v[64:67], v[16:31]
  s_waitcnt lgkmcnt(6)
  v_mfma_f32_32x32x16_bf16 v[16:31], v[244:247], v[68:71], v[16:31]
  s_waitcnt lgkmcnt(3)
  v_mfma_f32_32x32x16_bf16 v[16:31], v[248:251], v[72:75], v[16:31]
  s_waitcnt lgkmcnt(0)
  v_mfma_f32_32x32x16_bf16 v[16:31], v[252:255], v[76:79], v[16:31]
  s_nop 7
  s_nop 1
  v_cvt_pk_bf16_f32 v96, v16, v17
  v_cvt_pk_bf16_f32 v97, v18, v19
  v_cvt_pk_bf16_f32 v98, v20, v21
  v_cvt_pk_bf16_f32 v99, v22, v23
  v_cvt_pk_bf16_f32 v100, v24, v25
  v_cvt_pk_bf16_f32 v101, v26, v27
  v_cvt_pk_bf16_f32 v102, v28, v29
  v_cvt_pk_bf16_f32 v103, v30, v31
  s_nop 1
  v_permlane32_swap_b32 v96, v98
  v_permlane32_swap_b32 v97, v99
  v_permlane32_swap_b32 v100, v102
  v_permlane32_swap_b32 v101, v103
  s_mov_b64 exec, s[48:49]
  s_cbranch_execz L_NOMIX_0_0
  v_mov_b32 v104, v98
  v_mov_b32 v105, v99
  v_mov_b32 v106, s42
  v_mov_b32 v107, s43
  v_mov_b32 v98, s42
  v_mov_b32 v99, s43
  buffer_store_dwordx4 v[104:107], v130, s[8:11], s60 offen sc1
L_NOMIX_0_0:
  s_mov_b64 exec, -1
  buffer_store_dwordx4 v[96:99], v128, s[8:11], s60 offen sc1
  s_mov_b64 exec, s[50:51]
  s_cbranch_execz L_NOMIX_0_1
  v_mov_b32 v108, v102
  v_mov_b32 v109, v103
  v_mov_b32 v110, s42
  v_mov_b32 v111, s43
  v_mov_b32 v102, s42
  v_mov_b32 v103, s43
  buffer_store_dwordx4 v[108:111], v131, s[8:11], s60 offen sc1
L_NOMIX_0_1:
  s_mov_b64 exec, -1
  buffer_store_dwordx4 v[100:103], v129, s[8:11], s60 offen sc1
  s_barrier
  ds_read_b128 v[64:67], v8 offset:8192
  ds_read_b128 v[68:71], v9 offset:8192
  ds_read_b128 v[72:75], v10 offset:8192
  ds_read_b128 v[76:79], v11 offset:8192
  ds_read_b128 v[80:83], v8 offset:24576
  ds_read_b128 v[84:87], v9 offset:24576
  s_waitcnt lgkmcnt(5)
  v_mfma_f32_32x32x16_bf16 v[32:47], v[144:147], v[64:67], 0
  ds_read_b128 v[88:91], v10 offset:24576
  s_waitcnt lgkmcnt(5)
  v_mfma_f32_32x32x16_bf16 v[32:47], v[148:151], v[68:71], v[32:47]
  ds_read_b128 v[92:95], v11 offset:24576
  s_waitcnt lgkmcnt(5)
  v_mfma_f32_32x32x16_bf16 v[32:47], v[152:155], v[72:75], v[32:47]
  ds_read_b128 v[64:67], v8 offset:40960
  s_waitcnt lgkmcnt(5)
  v_mfma_f32_32x32x16_bf16 v[32:47], v[156:159], v[76:79], v[32:47]
  ds_read_b128 v[68:71], v9 offset:40960
  s_waitcnt lgkmcnt(5)
  v_mfma_f32_32x32x16_bf16 v[32:47], v[160:163], v[80:83], v[32:47]
  ds_read_b128 v[72:75], v10 offset:40960
  s_waitcnt lgkmcnt(5)
  v_mfma_f32_32x32x16_bf16 v[32:47], v[164:167], v[84:87], v[32:47]
  ds_read_b128 v[76:79], v11 offset:40960
  s_waitcnt lgkmcnt(5)
  v_mfma_f32_32x32x16_bf16 v[32:47], v[168:171], v[88:91], v[32:47]
  ds_read_b128 v[80:83], v8 offset:57344
  s_waitcnt lgkmcnt(5)
  v_mfma_f32_32x32x16_bf16 v[32:47], v[172:175], v[92:95], v[32:47]
  ds_read_b128 v[84:87], v9 offset:57344
  s_waitcnt lgkmcnt(5)
  v_mfma_f32_32x32x16_bf16 v[32:47], v[176:179], v[64:67], v[32:47]
  ds_read_b128 v[88:91], v10 offset:57344
  s_waitcnt lgkmcnt(5)
  v_mfma_f32_32x32x16_bf16 v[32:47], v[180:183], v[68:71], v[32:47]
  ds_read_b128 v[92:95], v11 offset:57344
  s_waitcnt lgkmcnt(5)
  v_mfma_f32_32x32x16_bf16 v[32:47], v[184:187], v[72:75], v[32:47]
  s_waitcnt lgkmcnt(4)
  v_mfma_f32_32x32x16_bf16 v[32:47], v[188:191], v[76:79], v[32:47]
  s_waitcnt lgkmcnt(3)
  v_mfma_f32_32x32x16_bf16 v[32:47], v[192:195], v[80:83], v[32:47]
  s_waitcnt lgkmcnt(2)
  v_mfma_f32_32x32x16_bf16 v[32:47], v[196:199], v[84:87], v[32:47]
  s_waitcnt lgkmcnt(1)
  v_mfma_f32_32x32x16_bf16 v[32:47], v[200:203], v[88:91], v[32:47]
  s_waitcnt lgkmcnt(0)
  v_mfma_f32_32x32x16_bf16 v[32:47], v[204:207], v[92:95], v[32:47]
  s_waitcnt vmcnt(0)
  s_mov_b64 exec, 1
  buffer_store_dword v138, v137, s[8:11], s62 offen sc1
  buffer_store_dword v138, v137, s[8:11], s33 offen sc1
  s_mov_b64 exec, -1
  s_barrier
  ds_read_b128 v[16:19], v136 offset:16384
  ds_read_b128 v[64:67], v52 offset:0
  ds_read_b128 v[20:23], v136 offset:17408
  ds_read_b128 v[68:71], v53 offset:0
  ds_read_b128 v[24:27], v136 offset:18432
  ds_read_b128 v[72:75], v54 offset:0
  ds_read_b128 v[28:31], v136 offset:19456
  ds_read_b128 v[76:79], v55 offset:0
  ds_read_b128 v[96:99], v136 offset:20480
  ds_read_b128 v[80:83], v52 offset:16384
  ds_read_b128 v[100:103], v136 offset:21504
  ds_read_b128 v[84:87], v53 offset:16384
  s_waitcnt lgkmcnt(10)
  v_mfma_f32_32x32x16_bf16 v[112:127], v[16:19], v[64:67], 0
  ds_read_b128 v[104:107], v136 offset:22528
  ds_read_b128 v[88:91], v54 offset:16384
  s_waitcnt lgkmcnt(10)
  v_mfma_f32_32x32x16_bf16 v[112:127], v[20:23], v[68:71], v[112:127]
  ds_read_b128 v[108:111], v136 offset:23552
  ds_read_b128 v[92:95], v55 offset:16384
  s_waitcnt lgkmcnt(10)
  v_mfma_f32_32x32x16_bf16 v[112:127], v[24:27], v[72:75], v[112:127]
  ds_read_b128 v[16:19], v136 offset:24576
  ds_read_b128 v[64:67], v52 offset:32768
  s_waitcnt lgkmcnt(10)
  v_mfma_f32_32x32x16_bf16 v[112:127], v[28:31], v[76:79], v[112:127]
  ds_read_b128 v[20:23], v136 offset:25600
  ds_read_b128 v[68:71], v53 offset:32768
  s_waitcnt lgkmcnt(10)
  v_mfma_f32_32x32x16_bf16 v[112:127], v[96:99], v[80:83], v[112:127]
  ds_read_b128 v[24:27], v136 offset:26624
  ds_read_b128 v[72:75], v54 offset:32768
  s_waitcnt lgkmcnt(10)
  v_mfma_f32_32x32x16_bf16 v[112:127], v[100:103], v[84:87], v[112:127]
  ds_read_b128 v[28:31], v136 offset:27648
  ds_read_b128 v[76:79], v55 offset:32768
  s_waitcnt lgkmcnt(10)
  v_mfma_f32_32x32x16_bf16 v[112:127], v[104:107], v[88:91], v[112:127]
  ds_read_b128 v[96:99], v136 offset:28672
  ds_read_b128 v[80:83], v52 offset:49152
  s_waitcnt lgkmcnt(10)
  v_mfma_f32_32x32x16_bf16 v[112:127], v[108:111], v[92:95], v[112:127]
  ds_read_b128 v[100:103], v136 offset:29696
  ds_read_b128 v[84:87], v53 offset:49152
  s_waitcnt lgkmcnt(10)
  v_mfma_f32_32x32x16_bf16 v[112:127], v[16:19], v[64:67], v[112:127]
  ds_read_b128 v[104:107], v136 offset:30720
  ds_read_b128 v[88:91], v54 offset:49152
  s_waitcnt lgkmcnt(10)
  v_mfma_f32_32x32x16_bf16 v[112:127], v[20:23], v[68:71], v[112:127]
  ds_read_b128 v[108:111], v136 offset:31744
  ds_read_b128 v[92:95], v55 offset:49152
  s_waitcnt lgkmcnt(10)
  v_mfma_f32_32x32x16_bf16 v[112:127], v[24:27], v[72:75], v[112:127]
  s_waitcnt lgkmcnt(8)
  v_mfma_f32_32x32x16_bf16 v[112:127], v[28:31], v[76:79], v[112:127]
  s_waitcnt lgkmcnt(6)
  v_mfma_f32_32x32x16_bf16 v[112:127], v[96:99], v[80:83], v[112:127]
  s_waitcnt lgkmcnt(4)
  v_mfma_f32_32x32x16_bf16 v[112:127], v[100:103], v[84:87], v[112:127]
  s_waitcnt lgkmcnt(2)
  v_mfma_f32_32x32x16_bf16 v[112:127], v[104:107], v[88:91], v[112:127]
  s_waitcnt lgkmcnt(0)
  v_mfma_f32_32x32x16_bf16 v[112:127], v[108:111], v[92:95], v[112:127]
  s_barrier
  s_mov_b64 exec, s[46:47]
  buffer_load_dword v143, v140, s[8:11], s41 offen sc1
  s_mov_b64 exec, -1
  ds_read_b128 v[64:67], v132 offset:8192
  ds_read_b128 v[68:71], v133 offset:8192
  ds_read_b128 v[72:75], v134 offset:8192
  ds_read_b128 v[76:79], v135 offset:8192
  ds_read_b128 v[80:83], v132 offset:24576
  ds_read_b128 v[84:87], v133 offset:24576
  s_waitcnt lgkmcnt(5)
  v_mfma_f32_32x32x16_bf16 v[32:47], v[208:211], v[64:67], v[32:47]
  ds_read_b128 v[88:91], v134 offset:24576
  s_waitcnt lgkmcnt(5)
  v_mfma_f32_32x32x16_bf16 v[32:47], v[212:215], v[68:71], v[32:47]
  ds_read_b128 v[92:95], v135 offset:24576
  s_waitcnt lgkmcnt(5)
  v_mfma_f32_32x32x16_bf16 v[32:47], v[216:219], v[72:75], v[32:47]
  ds_read_b128 v[64:67], v132 offset:40960
  s_waitcnt lgkmcnt(5)
  v_mfma_f32_32x32x16_bf16 v[32:47], v[220:223], v[76:79], v[32:47]
  ds_read_b128 v[68:71], v133 offset:40960
  s_waitcnt lgkmcnt(5)
  v_mfma_f32_32x32x16_bf16 v[32:47], v[224:227], v[80:83], v[32:47]
  ds_read_b128 v[72:75], v134 offset:40960
  s_waitcnt lgkmcnt(5)
  v_mfma_f32_32x32x16_bf16 v[32:47], v[228:231], v[84:87], v[32:47]
  ds_read_b128 v[76:79], v135 offset:40960
  s_waitcnt lgkmcnt(5)
  v_mfma_f32_32x32x16_bf16 v[32:47], v[232:235], v[88:91], v[32:47]
  s_waitcnt lgkmcnt(4)
  v_mfma_f32_32x32x16_bf16 v[32:47], v[236:239], v[92:95], v[32:47]
  s_waitcnt lgkmcnt(3)
  v_mfma_f32_32x32x16_bf16 v[32:47], v[240:243], v[64:67], v[32:47]
  s_waitcnt lgkmcnt(2)
  v_mfma_f32_32x32x16_bf16 v[32:47], v[244:247], v[68:71], v[32:47]
  s_waitcnt lgkmcnt(1)
  v_mfma_f32_32x32x16_bf16 v[32:47], v[248:251], v[72:75], v[32:47]
  s_waitcnt lgkmcnt(0)
  v_mfma_f32_32x32x16_bf16 v[32:47], v[252:255], v[76:79], v[32:47]
  s_nop 7
  s_nop 1
  v_cvt_pk_bf16_f32 v64, v32, v33
  v_cvt_pk_bf16_f32 v65, v34, v35
  v_cvt_pk_bf16_f32 v66, v36, v37
  v_cvt_pk_bf16_f32 v67, v38, v39
  v_cvt_pk_bf16_f32 v68, v40, v41
  v_cvt_pk_bf16_f32 v69, v42, v43
  v_cvt_pk_bf16_f32 v70, v44, v45
  v_cvt_pk_bf16_f32 v71, v46, v47
  s_nop 1
  v_permlane32_swap_b32 v64, v66
  v_permlane32_swap_b32 v65, v67
  v_permlane32_swap_b32 v68, v70
  v_permlane32_swap_b32 v69, v71
  s_mov_b64 exec, s[48:49]
  s_cbranch_execz L_NOMIX_1_0
  v_mov_b32 v72, v66
  v_mov_b32 v73, v67
  v_mov_b32 v74, s42
  v_mov_b32 v75, s43
  v_mov_b32 v66, s42
  v_mov_b32 v67, s43
  buffer_store_dwordx4 v[72:75], v130, s[8:11], s61 offen sc1
L_NOMIX_1_0:
  s_mov_b64 exec, -1
  buffer_store_dwordx4 v[64:67], v128, s[8:11], s61 offen sc1
  s_mov_b64 exec, s[50:51]
  s_cbranch_execz L_NOMIX_1_1
  v_mov_b32 v76, v70
  v_mov_b32 v77, v71
  v_mov_b32 v78, s42
  v_mov_b32 v79, s43
  v_mov_b32 v70, s42
  v_mov_b32 v71, s43
  buffer_store_dwordx4 v[76:79], v131, s[8:11], s61 offen sc1
L_NOMIX_1_1:
  s_mov_b64 exec, -1
  buffer_store_dwordx4 v[68:71], v129, s[8:11], s61 offen sc1
  s_or_b64 vcc, s[48:49], s[50:51]
  s_cbranch_scc1 L_KW3
  s_waitcnt vmcnt(2)
L_KW3:
  s_waitcnt vmcnt(3)
  s_branch L_QPHASE
L_VPART:
  s_sub_u32 s27, s26, 14
  s_lshl_b32 s27, s27, 5
  v_add_u32 v5, s27, v3
  v_mul_u32_u24 v6, 2341, v5
  v_lshrrev_b32 v6, 16, v6
  v_mul_u32_u24 v7, 28, v6
  v_sub_u32 v5, v5, v7
  v_cmp_le_u32 s[48:49], 24, v5
  v_cmp_eq_u32 vcc, 24, v5
  v_lshlrev_b32 v128, 18, v6
  v_lshl_add_u32 v5, v4, 5, v5
  v_lshl_add_u32 v128, v5, 4, v128
  v_mov_b32 v5, 0x3f803f80
  v_cndmask_b32 v48, 0, v5, vcc
  v_mov_b32 v49, v48
  v_mov_b32 v50, v48
  v_mov_b32 v51, v48
  s_barrier
  ds_read_b64_tr_b16 v[144:145], v12 offset:0
  ds_read_b64_tr_b16 v[146:147], v12 offset:512
  ds_read_b128 v[64:67], v8 offset:0
  ds_read_b64_tr_b16 v[148:149], v12 offset:2048
  ds_read_b64_tr_b16 v[150:151], v12 offset:2560
  ds_read_b128 v[68:71], v9 offset:0
  ds_read_b64_tr_b16 v[152:153], v12 offset:4096
  ds_read_b64_tr_b16 v[154:155], v12 offset:4608
  ds_read_b128 v[72:75], v10 offset:0
  ds_read_b64_tr_b16 v[156:157], v12 offset:6144
  ds_read_b64_tr_b16 v[158:159], v12 offset:6656
  ds_read_b128 v[76:79], v11 offset:0
  s_waitcnt lgkmcnt(9)
  v_mfma_f32_32x32x16_bf16 v[16:31], v[64:67], v[144:147], 0
  s_waitcnt lgkmcnt(6)
  v_mfma_f32_32x32x16_bf16 v[16:31], v[68:71], v[148:151], v[16:31]
  s_waitcnt lgkmcnt(3)
  v_mfma_f32_32x32x16_bf16 v[16:31], v[72:75], v[152:155], v[16:31]
  s_waitcnt lgkmcnt(0)
  v_mfma_f32_32x32x16_bf16 v[16:31], v[76:79], v[156:159], v[16:31]
  s_barrier
  ds_read_b64_tr_b16 v[160:161], v12 offset:8192
  ds_read_b64_tr_b16 v[162:163], v12 offset:8704
  ds_read_b128 v[64:67], v8 offset:16384
  ds_read_b64_tr_b16 v[164:165], v12 offset:10240
  ds_read_b64_tr_b16 v[166:167], v12 offset:10752
  ds_read_b128 v[68:71], v9 offset:16384
  ds_read_b64_tr_b16 v[168:169], v12 offset:12288
  ds_read_b64_tr_b16 v[170:171], v12 offset:12800
  ds_read_b128 v[72:75], v10 offset:16384
  ds_read_b64_tr_b16 v[172:173], v12 offset:14336
  ds_read_b64_tr_b16 v[174:175], v12 offset:14848
  ds_read_b128 v[76:79], v11 offset:16384
  s_waitcnt lgkmcnt(9)
  v_mfma_f32_32x32x16_bf16 v[16:31], v[64:67], v[160:163], v[16:31]
  s_waitcnt lgkmcnt(6)
  v_mfma_f32_32x32x16_bf16 v[16:31], v[68:71], v[164:167], v[16:31]
  s_waitcnt lgkmcnt(3)
  v_mfma_f32_32x32x16_bf16 v[16:31], v[72:75], v[168:171], v[16:31]
  s_waitcnt lgkmcnt(0)
  v_mfma_f32_32x32x16_bf16 v[16:31], v[76:79], v[172:175], v[16:31]
  s_barrier
  ds_read_b64_tr_b16 v[176:177], v12 offset:16384
  ds_read_b64_tr_b16 v[178:179], v12 offset:16896
  ds_read_b128 v[64:67], v8 offset:32768
  ds_read_b64_tr_b16 v[180:181], v12 offset:18432
  ds_read_b64_tr_b16 v[182:183], v12 offset:18944
  ds_read_b128 v[68:71], v9 offset:32768
  ds_read_b64_tr_b16 v[184:185], v12 offset:20480
  ds_read_b64_tr_b16 v[186:187], v12 offset:20992
  ds_read_b128 v[72:75], v10 offset:32768
  ds_read_b64_tr_b16 v[188:189], v12 offset:22528
  ds_read_b64_tr_b16 v[190:191], v12 offset:23040
  ds_read_b128 v[76:79], v11 offset:32768
  s_waitcnt lgkmcnt(9)
  v_mfma_f32_32x32x16_bf16 v[16:31], v[64:67], v[176:179], v[16:31]
  s_waitcnt lgkmcnt(6)
  v_mfma_f32_32x32x16_bf16 v[16:31], v[68:71], v[180:183], v[16:31]
  s_waitcnt lgkmcnt(3)
  v_mfma_f32_32x32x16_bf16 v[16:31], v[72:75], v[184:187], v[16:31]
  s_waitcnt lgkmcnt(0)
  v_mfma_f32_32x32x16_bf16 v[16:31], v[76:79], v[188:191], v[16:31]
  v_mov_b32 v96, -1
  v_mov_b32 v97, -1
  v_mov_b32 v98, -1
  v_mov_b32 v99, -1
  buffer_store_dwordx4 v[96:99], v139, s[8:11], s35 offen offset:0 sc1
  buffer_store_dwordx4 v[96:99], v139, s[8:11], s35 offen offset:1024 sc1
  s_barrier
  ds_read_b64_tr_b16 v[192:193], v12 offset:24576
  ds_read_b64_tr_b16 v[194:195], v12 offset:25088
  ds_read_b128 v[64:67], v8 offset:49152
  ds_read_b64_tr_b16 v[196:197], v12 offset:26624
  ds_read_b64_tr_b16 v[198:199], v12 offset:27136
  ds_read_b128 v[68:71], v9 offset:49152
  ds_read_b64_tr_b16 v[200:201], v12 offset:28672
  ds_read_b64_tr_b16 v[202:203], v12 offset:29184
  ds_read_b128 v[72:75], v10 offset:49152
  ds_read_b64_tr_b16 v[204:205], v12 offset:30720
  ds_read_b64_tr_b16 v[206:207], v12 offset:31232
  ds_read_b128 v[76:79], v11 offset:49152
  s_waitcnt lgkmcnt(9)
  v_mfma_f32_32x32x16_bf16 v[16:31], v[64:67], v[192:195], v[16:31]
  s_waitcnt lgkmcnt(6)
  v_mfma_f32_32x32x16_bf16 v[16:31], v[68:71], v[196:199], v[16:31]
  s_waitcnt lgkmcnt(3)
  v_mfma_f32_32x32x16_bf16 v[16:31], v[72:75], v[200:203], v[16:31]
  s_waitcnt lgkmcnt(0)
  v_mfma_f32_32x32x16_bf16 v[16:31], v[76:79], v[204:207], v[16:31]
  s_barrier
  ds_read_b64_tr_b16 v[208:209], v12 offset:32768
  ds_read_b64_tr_b16 v[210:211], v12 offset:33280
  ds_read_b128 v[64:67], v132 offset:0
  ds_read_b64_tr_b16 v[212:213], v12 offset:34816
  ds_read_b64_tr_b16 v[214:215], v12 offset:35328
  ds_read_b128 v[68:71], v133 offset:0
  ds_read_b64_tr_b16 v[216:217], v12 offset:36864
  ds_read_b64_tr_b16 v[218:219], v12 offset:37376
  ds_read_b128 v[72:75], v134 offset:0
  ds_read_b64_tr_b16 v[220:221], v12 offset:38912
  ds_read_b64_tr_b16 v[222:223], v12 offset:39424
  ds_read_b128 v[76:79], v135 offset:0
  s_waitcnt lgkmcnt(9)
  v_mfma_f32_32x32x16_bf16 v[16:31], v[64:67], v[208:211], v[16:31]
  s_waitcnt lgkmcnt(6)
  v_mfma_f32_32x32x16_bf16 v[16:31], v[68:71], v[212:215], v[16:31]
  s_waitcnt lgkmcnt(3)
  v_mfma_f32_32x32x16_bf16 v[16:31], v[72:75], v[216:219], v[16:31]
  s_waitcnt lgkmcnt(0)
  v_mfma_f32_32x32x16_bf16 v[16:31], v[76:79], v[220:223], v[16:31]
  s_barrier
  ds_read_b64_tr_b16 v[224:225], v12 offset:0
  ds_read_b64_tr_b16 v[226:227], v12 offset:512
  ds_read_b128 v[64:67], v132 offset:16384
  ds_read_b64_tr_b16 v[228:229], v12 offset:2048
  ds_read_b64_tr_b16 v[230:231], v12 offset:2560
  ds_read_b128 v[68:71], v133 offset:16384
  ds_read_b64_tr_b16 v[232:233], v12 offset:4096
  ds_read_b64_tr_b16 v[234:235], v12 offset:4608
  ds_read_b128 v[72:75], v134 offset:16384
  ds_read_b64_tr_b16 v[236:237], v12 offset:6144
  ds_read_b64_tr_b16 v[238:239], v12 offset:6656
  ds_read_b128 v[76:79], v135 offset:16384
  s_waitcnt lgkmcnt(9)
  v_mfma_f32_32x32x16_bf16 v[16:31], v[64:67], v[224:227], v[16:31]
  s_waitcnt lgkmcnt(6)
  v_mfma_f32_32x32x16_bf16 v[16:31], v[68:71], v[228:231], v[16:31]
  s_waitcnt lgkmcnt(3)
  v_mfma_f32_32x32x16_bf16 v[16:31], v[72:75], v[232:235], v[16:31]
  s_waitcnt lgkmcnt(0)
  v_mfma_f32_32x32x16_bf16 v[16:31], v[76:79], v[236:239], v[16:31]
  s_barrier
  ds_read_b64_tr_b16 v[240:241], v12 offset:8192
  ds_read_b64_tr_b16 v[242:243], v12 offset:8704
  ds_read_b128 v[64:67], v132 offset:32768
  ds_read_b64_tr_b16 v[244:245], v12 offset:10240
  ds_read_b64_tr_b16 v[246:247], v12 offset:10752
  ds_read_b128 v[68:71], v133 offset:32768
  ds_read_b64_tr_b16 v[248:249], v12 offset:12288
  ds_read_b64_tr_b16 v[250:251], v12 offset:12800
  ds_read_b128 v[72:75], v134 offset:32768
  ds_read_b64_tr_b16 v[252:253], v12 offset:14336
  ds_read_b64_tr_b16 v[254:255], v12 offset:14848
  ds_read_b128 v[76:79], v135 offset:32768
  s_waitcnt lgkmcnt(9)
  v_mfma_f32_32x32x16_bf16 v[16:31], v[64:67], v[240:243], v[16:31]
  s_waitcnt lgkmcnt(6)
  v_mfma_f32_32x32x16_bf16 v[16:31], v[68:71], v[244:247], v[16:31]
  s_waitcnt lgkmcnt(3)
  v_mfma_f32_32x32x16_bf16 v[16:31], v[72:75], v[248:251], v[16:31]
  s_waitcnt lgkmcnt(0)
  v_mfma_f32_32x32x16_bf16 v[16:31], v[76:79], v[252:255], v[16:31]
  s_nop 7
  s_nop 1
  v_cvt_pk_bf16_f32 v96, v16, v17
  v_cvt_pk_bf16_f32 v97, v18, v19
  v_cvt_pk_bf16_f32 v98, v20, v21
  v_cvt_pk_bf16_f32 v99, v22, v23
  v_cvt_pk_bf16_f32 v100, v24, v25
  v_cvt_pk_bf16_f32 v101, v26, v27
  v_cvt_pk_bf16_f32 v102, v28, v29
  v_cvt_pk_bf16_f32 v103, v30, v31
  buffer_store_dwordx4 v[96:99], v128, s[8:11], s60 offen offset:2048 sc1
  buffer_store_dwordx4 v[100:103], v128, s[8:11], s60 offen offset:3072 sc1
  s_mov_b64 exec, s[48:49]
  buffer_store_dwordx4 v[48:51], v128, s[8:11], s60 offen offset:2112 sc1
  buffer_store_dwordx4 v[48:51], v128, s[8:11], s60 offen offset:3136 sc1
  s_mov_b64 exec, -1
  s_barrier
  ds_read_b128 v[64:67], v8 offset:8192
  ds_read_b128 v[68:71], v9 offset:8192
  ds_read_b128 v[72:75], v10 offset:8192
  ds_read_b128 v[76:79], v11 offset:8192
  ds_read_b128 v[80:83], v8 offset:24576
  ds_read_b128 v[84:87], v9 offset:24576
  s_waitcnt lgkmcnt(5)
  v_mfma_f32_32x32x16_bf16 v[32:47], v[64:67], v[144:147], 0
  ds_read_b128 v[88:91], v10 offset:24576
  s_waitcnt lgkmcnt(5)
  v_mfma_f32_32x32x16_bf16 v[32:47], v[68:71], v[148:151], v[32:47]
  ds_read_b128 v[92:95], v11 offset:24576
  s_waitcnt lgkmcnt(5)
  v_mfma_f32_32x32x16_bf16 v[32:47], v[72:75], v[152:155], v[32:47]
  ds_read_b128 v[64:67], v8 offset:40960
  s_waitcnt lgkmcnt(5)
  v_mfma_f32_32x32x16_bf16 v[32:47], v[76:79], v[156:159], v[32:47]
  ds_read_b128 v[68:71], v9 offset:40960
  s_waitcnt lgkmcnt(5)
  v_mfma_f32_32x32x16_bf16 v[32:47], v[80:83], v[160:163], v[32:47]
  ds_read_b128 v[72:75], v10 offset:40960
  s_waitcnt lgkmcnt(5)
  v_mfma_f32_32x32x16_bf16 v[32:47], v[84:87], v[164:167], v[32:47]
  ds_read_b128 v[76:79], v11 offset:40960
  s_waitcnt lgkmcnt(5)
  v_mfma_f32_32x32x16_bf16 v[32:47], v[88:91], v[168:171], v[32:47]
  ds_read_b128 v[80:83], v8 offset:57344
  s_waitcnt lgkmcnt(5)
  v_mfma_f32_32x32x16_bf16 v[32:47], v[92:95], v[172:175], v[32:47]
  ds_read_b128 v[84:87], v9 offset:57344
  s_waitcnt lgkmcnt(5)
  v_mfma_f32_32x32x16_bf16 v[32:47], v[64:67], v[176:179], v[32:47]
  ds_read_b128 v[88:91], v10 offset:57344
  s_waitcnt lgkmcnt(5)
  v_mfma_f32_32x32x16_bf16 v[32:47], v[68:71], v[180:183], v[32:47]
  ds_read_b128 v[92:95], v11 offset:57344
  s_waitcnt lgkmcnt(5)
  v_mfma_f32_32x32x16_bf16 v[32:47], v[72:75], v[184:187], v[32:47]
  s_waitcnt lgkmcnt(4)
  v_mfma_f32_32x32x16_bf16 v[32:47], v[76:79], v[188:191], v[32:47]
  s_waitcnt lgkmcnt(3)
  v_mfma_f32_32x32x16_bf16 v[32:47], v[80:83], v[192:195], v[32:47]
  s_waitcnt lgkmcnt(2)
  v_mfma_f32_32x32x16_bf16 v[32:47], v[84:87], v[196:199], v[32:47]
  s_waitcnt lgkmcnt(1)
  v_mfma_f32_32x32x16_bf16 v[32:47], v[88:91], v[200:203], v[32:47]
  s_waitcnt lgkmcnt(0)
  v_mfma_f32_32x32x16_bf16 v[32:47], v[92:95], v[204:207], v[32:47]
  s_waitcnt vmcnt(0)
  s_mov_b64 exec, 1
  buffer_store_dword v138, v137, s[8:11], s62 offen sc1
  buffer_store_dword v138, v137, s[8:11], s33 offen sc1
  s_mov_b64 exec, -1
  s_barrier
  ds_read_b128 v[16:19], v136 offset:16384
  ds_read_b128 v[64:67], v52 offset:0
  ds_read_b128 v[20:23], v136 offset:17408
  ds_read_b128 v[68:71], v53 offset:0
  ds_read_b128 v[24:27], v136 offset:18432
  ds_read_b128 v[72:75], v54 offset:0
  ds_read_b128 v[28:31], v136 offset:19456
  ds_read_b128 v[76:79], v55 offset:0
  ds_read_b128 v[96:99], v136 offset:20480
  ds_read_b128 v[80:83], v52 offset:16384
  ds_read_b128 v[100:103], v136 offset:21504
  ds_read_b128 v[84:87], v53 offset:16384
  s_waitcnt lgkmcnt(10)
  v_mfma_f32_32x32x16_bf16 v[112:127], v[16:19], v[64:67], 0
  ds_read_b128 v[104:107], v136 offset:22528
  ds_read_b128 v[88:91], v54 offset:16384
  s_waitcnt lgkmcnt(10)
  v_mfma_f32_32x32x16_bf16 v[112:127], v[20:23], v[68:71], v[112:127]
  ds_read_b128 v[108:111], v136 offset:23552
  ds_read_b128 v[92:95], v55 offset:16384
  s_waitcnt lgkmcnt(10)
  v_mfma_f32_32x32x16_bf16 v[112:127], v[24:27], v[72:75], v[112:127]
  ds_read_b128 v[16:19], v136 offset:24576
  ds_read_b128 v[64:67], v52 offset:32768
  s_waitcnt lgkmcnt(10)
  v_mfma_f32_32x32x16_bf16 v[112:127], v[28:31], v[76:79], v[112:127]
  ds_read_b128 v[20:23], v136 offset:25600
  ds_read_b128 v[68:71], v53 offset:32768
  s_waitcnt lgkmcnt(10)
  v_mfma_f32_32x32x16_bf16 v[112:127], v[96:99], v[80:83], v[112:127]
  ds_read_b128 v[24:27], v136 offset:26624
  ds_read_b128 v[72:75], v54 offset:32768
  s_waitcnt lgkmcnt(10)
  v_mfma_f32_32x32x16_bf16 v[112:127], v[100:103], v[84:87], v[112:127]
  ds_read_b128 v[28:31], v136 offset:27648
  ds_read_b128 v[76:79], v55 offset:32768
  s_waitcnt lgkmcnt(10)
  v_mfma_f32_32x32x16_bf16 v[112:127], v[104:107], v[88:91], v[112:127]
  ds_read_b128 v[96:99], v136 offset:28672
  ds_read_b128 v[80:83], v52 offset:49152
  s_waitcnt lgkmcnt(10)
  v_mfma_f32_32x32x16_bf16 v[112:127], v[108:111], v[92:95], v[112:127]
  ds_read_b128 v[100:103], v136 offset:29696
  ds_read_b128 v[84:87], v53 offset:49152
  s_waitcnt lgkmcnt(10)
  v_mfma_f32_32x32x16_bf16 v[112:127], v[16:19], v[64:67], v[112:127]
  ds_read_b128 v[104:107], v136 offset:30720
  ds_read_b128 v[88:91], v54 offset:49152
  s_waitcnt lgkmcnt(10)
  v_mfma_f32_32x32x16_bf16 v[112:127], v[20:23], v[68:71], v[112:127]
  ds_read_b128 v[108:111], v136 offset:31744
  ds_read_b128 v[92:95], v55 offset:49152
  s_waitcnt lgkmcnt(10)
  v_mfma_f32_32x32x16_bf16 v[112:127], v[24:27], v[72:75], v[112:127]
  s_waitcnt lgkmcnt(8)
  v_mfma_f32_32x32x16_bf16 v[112:127], v[28:31], v[76:79], v[112:127]
  s_waitcnt lgkmcnt(6)
  v_mfma_f32_32x32x16_bf16 v[112:127], v[96:99], v[80:83], v[112:127]
  s_waitcnt lgkmcnt(4)
  v_mfma_f32_32x32x16_bf16 v[112:127], v[100:103], v[84:87], v[112:127]
  s_waitcnt lgkmcnt(2)
  v_mfma_f32_32x32x16_bf16 v[112:127], v[104:107], v[88:91], v[112:127]
  s_waitcnt lgkmcnt(0)
  v_mfma_f32_32x32x16_bf16 v[112:127], v[108:111], v[92:95], v[112:127]
  s_barrier
  s_mov_b64 exec, s[46:47]
  buffer_load_dword v143, v140, s[8:11], s41 offen sc1
  s_mov_b64 exec, -1
  ds_read_b128 v[64:67], v132 offset:8192
  ds_read_b128 v[68:71], v133 offset:8192
  ds_read_b128 v[72:75], v134 offset:8192
  ds_read_b128 v[76:79], v135 offset:8192
  ds_read_b128 v[80:83], v132 offset:24576
  ds_read_b128 v[84:87], v133 offset:24576
  s_waitcnt lgkmcnt(5)
  v_mfma_f32_32x32x16_bf16 v[32:47], v[64:67], v[208:211], v[32:47]
  ds_read_b128 v[88:91], v134 offset:24576
  s_waitcnt lgkmcnt(5)
  v_mfma_f32_32x32x16_bf16 v[32:47], v[68:71], v[212:215], v[32:47]
  ds_read_b128 v[92:95], v135 offset:24576
  s_waitcnt lgkmcnt(5)
  v_mfma_f32_32x32x16_bf16 v[32:47], v[72:75], v[216:219], v[32:47]
  ds_read_b128 v[64:67], v132 offset:40960
  s_waitcnt lgkmcnt(5)
  v_mfma_f32_32x32x16_bf16 v[32:47], v[76:79], v[220:223], v[32:47]
  ds_read_b128 v[68:71], v133 offset:40960
  s_waitcnt lgkmcnt(5)
  v_mfma_f32_32x32x16_bf16 v[32:47], v[80:83], v[224:227], v[32:47]
  ds_read_b128 v[72:75], v134 offset:40960
  s_waitcnt lgkmcnt(5)
  v_mfma_f32_32x32x16_bf16 v[32:47], v[84:87], v[228:231], v[32:47]
  ds_read_b128 v[76:79], v135 offset:40960
  s_waitcnt lgkmcnt(5)
  v_mfma_f32_32x32x16_bf16 v[32:47], v[88:91], v[232:235], v[32:47]
  s_waitcnt lgkmcnt(4)
  v_mfma_f32_32x32x16_bf16 v[32:47], v[92:95], v[236:239], v[32:47]
  s_waitcnt lgkmcnt(3)
  v_mfma_f32_32x32x16_bf16 v[32:47], v[64:67], v[240:243], v[32:47]
  s_waitcnt lgkmcnt(2)
  v_mfma_f32_32x32x16_bf16 v[32:47], v[68:71], v[244:247], v[32:47]
  s_waitcnt lgkmcnt(1)
  v_mfma_f32_32x32x16_bf16 v[32:47], v[72:75], v[248:251], v[32:47]
  s_waitcnt lgkmcnt(0)
  v_mfma_f32_32x32x16_bf16 v[32:47], v[76:79], v[252:255], v[32:47]
  s_nop 7
  s_nop 1
  v_cvt_pk_bf16_f32 v64, v32, v33
  v_cvt_pk_bf16_f32 v65, v34, v35
  v_cvt_pk_bf16_f32 v66, v36, v37
  v_cvt_pk_bf16_f32 v67, v38, v39
  v_cvt_pk_bf16_f32 v68, v40, v41
  v_cvt_pk_bf16_f32 v69, v42, v43
  v_cvt_pk_bf16_f32 v70, v44, v45
  v_cvt_pk_bf16_f32 v71, v46, v47
  buffer_store_dwordx4 v[64:67], v128, s[8:11], s61 offen offset:2048 sc1
  buffer_store_dwordx4 v[68:71], v128, s[8:11], s61 offen offset:3072 sc1
  s_mov_b64 exec, s[48:49]
  buffer_store_dwordx4 v[48:51], v128, s[8:11], s61 offen offset:2112 sc1
  buffer_store_dwordx4 v[48:51], v128, s[8:11], s61 offen offset:3136 sc1
  s_mov_b64 exec, -1
  s_waitcnt vmcnt(4)
  s_branch L_QPHASE
L_RPK:
  s_sub_u32 s27, s22, 14
  s_lshl_b32 s27, s27, 4
  s_add_u32 s27, s27, s25
  s_mul_i32 s29, s3, 114688
  s_lshl_b32 s40, s27, 10
  s_add_u32 s29, s29, s40
  buffer_load_dword v64, v137, s[8:11], s29 offen sc1
  s_lshl_b32 s62, s27, 7
  s_lshl_b32 s40, s3, 12
  s_add_u32 s62, s62, s40
  s_add_u32 s62, s62, 8589312
  s_waitcnt vmcnt(0)
  s_barrier
  ds_read_b64_tr_b16 v[64:65], v141 offset:0
  ds_read_b64_tr_b16 v[66:67], v141 offset:4096
  ds_read_b64_tr_b16 v[68:69], v142 offset:56
  ds_read_b64_tr_b16 v[70:71], v142 offset:4152
  ds_read_b64_tr_b16 v[72:73], v141 offset:112
  ds_read_b64_tr_b16 v[74:75], v141 offset:4208
  ds_read_b64_tr_b16 v[76:77], v142 offset:168
  ds_read_b64_tr_b16 v[78:79], v142 offset:4264
  s_cmp_ge_u32 s27, 28
  s_cbranch_scc1 L_RPKSKIP
  s_waitcnt lgkmcnt(6)
  buffer_store_dwordx4 v[64:67], v139, s[8:11], s29 offen sc1
  s_add_u32 s29, s29, 28672
  s_waitcnt lgkmcnt(4)
  buffer_store_dwordx4 v[68:71], v139, s[8:11], s29 offen sc1
  s_add_u32 s29, s29, 28672
  s_waitcnt lgkmcnt(2)
  buffer_store_dwordx4 v[72:75], v139, s[8:11], s29 offen sc1
  s_add_u32 s29, s29, 28672
  s_waitcnt lgkmcnt(0)
  buffer_store_dwordx4 v[76:79], v139, s[8:11], s29 offen sc1
  s_add_u32 s29, s29, 28672
L_RPKSKIP:
  s_waitcnt lgkmcnt(0)
  s_waitcnt vmcnt(0)
  s_mov_b64 exec, 1
  buffer_store_dword v138, v137, s[8:11], s62 offen sc1
  s_mov_b64 exec, -1
  s_barrier
  v_mov_b32 v96, -1
  v_mov_b32 v97, -1
  v_mov_b32 v98, -1
  v_mov_b32 v99, -1
  buffer_store_dwordx4 v[96:99], v139, s[8:11], s35 offen offset:0 sc1
  buffer_store_dwordx4 v[96:99], v139, s[8:11], s35 offen offset:1024 sc1
  s_barrier
  s_waitcnt vmcnt(0)
  s_mov_b64 exec, 1
  buffer_store_dword v138, v137, s[8:11], s33 offen sc1
  s_mov_b64 exec, -1
  s_barrier
  ds_read_b128 v[16:19], v136 offset:16384
  ds_read_b128 v[64:67], v52 offset:0
  ds_read_b128 v[20:23], v136 offset:17408
  ds_read_b128 v[68:71], v53 offset:0
  ds_read_b128 v[24:27], v136 offset:18432
  ds_read_b128 v[72:75], v54 offset:0
  ds_read_b128 v[28:31], v136 offset:19456
  ds_read_b128 v[76:79], v55 offset:0
  ds_read_b128 v[96:99], v136 offset:20480
  ds_read_b128 v[80:83], v52 offset:16384
  ds_read_b128 v[100:103], v136 offset:21504
  ds_read_b128 v[84:87], v53 offset:16384
  s_waitcnt lgkmcnt(10)
  v_mfma_f32_32x32x16_bf16 v[112:127], v[16:19], v[64:67], 0
  ds_read_b128 v[104:107], v136 offset:22528
  ds_read_b128 v[88:91], v54 offset:16384
  s_waitcnt lgkmcnt(10)
  v_mfma_f32_32x32x16_bf16 v[112:127], v[20:23], v[68:71], v[112:127]
  ds_read_b128 v[108:111], v136 offset:23552
  ds_read_b128 v[92:95], v55 offset:16384
  s_waitcnt lgkmcnt(10)
  v_mfma_f32_32x32x16_bf16 v[112:127], v[24:27], v[72:75], v[112:127]
  ds_read_b128 v[16:19], v136 offset:24576
  ds_read_b128 v[64:67], v52 offset:32768
  s_waitcnt lgkmcnt(10)
  v_mfma_f32_32x32x16_bf16 v[112:127], v[28:31], v[76:79], v[112:127]
  ds_read_b128 v[20:23], v136 offset:25600
  ds_read_b128 v[68:71], v53 offset:32768
  s_waitcnt lgkmcnt(10)
  v_mfma_f32_32x32x16_bf16 v[112:127], v[96:99], v[80:83], v[112:127]
  ds_read_b128 v[24:27], v136 offset:26624
  ds_read_b128 v[72:75], v54 offset:32768
  s_waitcnt lgkmcnt(10)
  v_mfma_f32_32x32x16_bf16 v[112:127], v[100:103], v[84:87], v[112:127]
  ds_read_b128 v[28:31], v136 offset:27648
  ds_read_b128 v[76:79], v55 offset:32768
  s_waitcnt lgkmcnt(10)
  v_mfma_f32_32x32x16_bf16 v[112:127], v[104:107], v[88:91], v[112:127]
  ds_read_b128 v[96:99], v136 offset:28672
  ds_read_b128 v[80:83], v52 offset:49152
  s_waitcnt lgkmcnt(10)
  v_mfma_f32_32x32x16_bf16 v[112:127], v[108:111], v[92:95], v[112:127]
  ds_read_b128 v[100:103], v136 offset:29696
  ds_read_b128 v[84:87], v53 offset:49152
  s_waitcnt lgkmcnt(10)
  v_mfma_f32_32x32x16_bf16 v[112:127], v[16:19], v[64:67], v[112:127]
  ds_read_b128 v[104:107], v136 offset:30720
  ds_read_b128 v[88:91], v54 offset:49152
  s_waitcnt lgkmcnt(10)
  v_mfma_f32_32x32x16_bf16 v[112:127], v[20:23], v[68:71], v[112:127]
  ds_read_b128 v[108:111], v136 offset:31744
  ds_read_b128 v[92:95], v55 offset:49152
  s_waitcnt lgkmcnt(10)
  v_mfma_f32_32x32x16_bf16 v[112:127], v[24:27], v[72:75], v[112:127]
  s_waitcnt lgkmcnt(8)
  v_mfma_f32_32x32x16_bf16 v[112:127], v[28:31], v[76:79], v[112:127]
  s_waitcnt lgkmcnt(6)
  v_mfma_f32_32x32x16_bf16 v[112:127], v[96:99], v[80:83], v[112:127]
  s_waitcnt lgkmcnt(4)
  v_mfma_f32_32x32x16_bf16 v[112:127], v[100:103], v[84:87], v[112:127]
  s_waitcnt lgkmcnt(2)
  v_mfma_f32_32x32x16_bf16 v[112:127], v[104:107], v[88:91], v[112:127]
  s_waitcnt lgkmcnt(0)
  v_mfma_f32_32x32x16_bf16 v[112:127], v[108:111], v[92:95], v[112:127]
  s_barrier
  s_mov_b64 exec, s[46:47]
  buffer_load_dword v143, v140, s[8:11], s41 offen sc1
  s_mov_b64 exec, -1
  s_waitcnt vmcnt(0)
L_QPHASE:
  v_mov_b32 v3, v139
  v_add_u32 v248, 0, v3
  v_add_u32 v249, 4096, v3
  v_add_u32 v250, 8192, v3
  v_add_u32 v251, 12288, v3
  s_mov_b32 s34, 0
  s_lshl_b32 s23, s24, 18
  s_add_u32 s23, s23, 2097152
  s_lshl_b32 s27, s3, 16
  s_add_u32 s27, s27, s23
  s_add_u32 s12, s6, s27
  s_addc_u32 s13, s7, 0
  s_mov_b32 s14, 65536
  s_mov_b32 s15, 0x00020000
  s_add_u32 s27, s3, 1
  s_and_b32 s27, s27, 3
  s_mul_i32 s27, s27, 12288
  s_add_u32 s27, s27, 65536
  v_add_u32 v4, s27, v3
  s_add_u32 s27, s3, 2
  s_and_b32 s27, s27, 3
  s_mul_i32 s27, s27, 12288
  s_add_u32 s27, s27, 69632
  v_add_u32 v5, s27, v3
  s_add_u32 s27, s3, 3
  s_and_b32 s27, s27, 3
  s_mul_i32 s27, s27, 12288
  s_add_u32 s27, s27, 73728
  v_add_u32 v6, s27, v3
  s_mul_i32 s27, s3, 12288
  s_add_u32 s27, s27, 65536
  v_add_u32 v7, s27, v3
  s_mov_b32 s28, 0
  s_mov_b32 s29, -1
  v_mov_b32 v132, v56
  v_mov_b32 v133, v57
  v_mov_b32 v134, v58
  v_mov_b32 v135, v59
  v_cmp_ne_u32 vcc, s63, v143
  s_nop 1
  s_and_b64 vcc, vcc, s[46:47]
  s_cselect_b32 s40, 1, 0
  s_cbranch_scc1 L_ARETRY
  buffer_load_dwordx4 v[208:211], v3, s[8:11], s23 offen offset:0 sc1
  buffer_load_dwordx4 v[212:215], v3, s[8:11], s23 offen offset:1024 sc1
  buffer_load_dwordx4 v[144:147], v248, s[12:15], 0 offen offset:0 sc1
  buffer_load_dwordx4 v[148:151], v248, s[12:15], 0 offen offset:1024 sc1
  buffer_load_dwordx4 v[152:155], v248, s[12:15], 0 offen offset:2048 sc1
  buffer_load_dwordx4 v[156:159], v248, s[12:15], 0 offen offset:3072 sc1
  s_branch L_ADONE1
L_ARETRY:
  s_mov_b64 exec, s[46:47]
  buffer_load_dword v143, v140, s[8:11], s41 offen sc1
  s_mov_b64 exec, -1
L_ADONE1:
  ds_read_b128 v[160:163], v136 offset:0
  ds_read_b128 v[216:219], v132 offset:0
  ds_read_b128 v[164:167], v136 offset:1024
  ds_read_b128 v[220:223], v133 offset:0
  ds_read_b128 v[168:171], v136 offset:2048
  ds_read_b128 v[224:227], v134 offset:0
  ds_read_b128 v[172:175], v136 offset:3072
  ds_read_b128 v[228:231], v135 offset:0
  ds_read_b128 v[176:179], v136 offset:4096
  ds_read_b128 v[232:235], v132 offset:16384
  ds_read_b128 v[180:183], v136 offset:5120
  ds_read_b128 v[236:239], v133 offset:16384
  s_waitcnt lgkmcnt(10)
  v_mfma_f32_32x32x16_bf16 v[112:127], v[160:163], v[216:219], v[112:127]
  v_mov_b32 v40, 0
  v_mov_b32 v41, 0
  v_mov_b32 v42, 0
  v_mov_b32 v43, 0
  v_mov_b32 v44, 0
  v_mov_b32 v45, 0
  ds_read_b128 v[184:187], v136 offset:6144
  ds_read_b128 v[240:243], v134 offset:16384
  s_waitcnt lgkmcnt(10)
  v_mfma_f32_32x32x16_bf16 v[112:127], v[164:167], v[220:223], v[112:127]
  v_mov_b32 v46, 0
  v_mov_b32 v47, 0
  v_mov_b32 v48, 0
  v_mov_b32 v49, 0
  v_mov_b32 v50, 0
  v_mov_b32 v51, 0
  ds_read_b128 v[188:191], v136 offset:7168
  ds_read_b128 v[244:247], v135 offset:16384
  s_waitcnt lgkmcnt(10)
  v_mfma_f32_32x32x16_bf16 v[112:127], v[168:171], v[224:227], v[112:127]
  v_mov_b32 v52, 0
  v_mov_b32 v53, 0
  v_mov_b32 v54, 0
  v_mov_b32 v55, 0
  v_mov_b32 v56, 0
  v_mov_b32 v57, 0
  ds_read_b128 v[160:163], v136 offset:8192
  ds_read_b128 v[216:219], v132 offset:32768
  s_waitcnt lgkmcnt(10)
  v_mfma_f32_32x32x16_bf16 v[112:127], v[172:175], v[228:231], v[112:127]
  v_mov_b32 v58, 0
  v_mov_b32 v59, 0
  v_mov_b32 v60, 0
  v_mov_b32 v61, 0
  v_mov_b32 v62, 0
  v_mov_b32 v63, 0
  ds_read_b128 v[164:167], v136 offset:9216
  ds_read_b128 v[220:223], v133 offset:32768
  s_waitcnt lgkmcnt(10)
  v_mfma_f32_32x32x16_bf16 v[112:127], v[176:179], v[232:235], v[112:127]
  v_mov_b32 v64, 0
  v_mov_b32 v65, 0
  v_mov_b32 v66, 0
  v_mov_b32 v67, 0
  v_mov_b32 v68, 0
  v_mov_b32 v69, 0
  ds_read_b128 v[168:171], v136 offset:10240
  ds_read_b128 v[224:227], v134 offset:32768
  s_waitcnt lgkmcnt(10)
  v_mfma_f32_32x32x16_bf16 v[112:127], v[180:183], v[236:239], v[112:127]
  v_mov_b32 v70, 0
  v_mov_b32 v71, 0
  v_mov_b32 v72, 0
  v_mov_b32 v73, 0
  v_mov_b32 v74, 0
  v_mov_b32 v75, 0
  ds_read_b128 v[172:175], v136 offset:11264
  ds_read_b128 v[228:231], v135 offset:32768
  s_waitcnt lgkmcnt(10)
  v_mfma_f32_32x32x16_bf16 v[112:127], v[184:187], v[240:243], v[112:127]
  v_mov_b32 v76, 0
  v_mov_b32 v77, 0
  v_mov_b32 v78, 0
  v_mov_b32 v79, 0
  v_mov_b32 v80, 0
  v_mov_b32 v81, 0
  s_waitcnt lgkmcnt(8)
  v_mfma_f32_32x32x16_bf16 v[112:127], v[188:191], v[244:247], v[112:127]
  v_mov_b32 v82, 0
  v_mov_b32 v83, 0
  v_mov_b32 v84, 0
  v_mov_b32 v85, 0
  v_mov_b32 v86, 0
  v_mov_b32 v87, 0
  s_waitcnt lgkmcnt(6)
  v_mfma_f32_32x32x16_bf16 v[112:127], v[160:163], v[216:219], v[112:127]
  v_mov_b32 v88, 0
  v_mov_b32 v89, 0
  v_mov_b32 v90, 0
  v_mov_b32 v91, 0
  v_mov_b32 v92, 0
  v_mov_b32 v93, 0
  s_waitcnt lgkmcnt(4)
  v_mfma_f32_32x32x16_bf16 v[112:127], v[164:167], v[220:223], v[112:127]
  v_mov_b32 v94, 0
  v_mov_b32 v95, 0
  v_mov_b32 v96, 0
  v_mov_b32 v97, 0
  v_mov_b32 v98, 0
  v_mov_b32 v99, 0
  s_waitcnt lgkmcnt(2)
  v_mfma_f32_32x32x16_bf16 v[112:127], v[168:171], v[224:227], v[112:127]
  v_mov_b32 v100, 0
  v_mov_b32 v101, 0
  v_mov_b32 v102, 0
  v_mov_b32 v103, 0
  v_mov_b32 v204, 0
  v_mov_b32 v205, 0
  s_waitcnt lgkmcnt(0)
  v_mfma_f32_32x32x16_bf16 v[112:127], v[172:175], v[228:231], v[112:127]
  v_mov_b32 v206, 0
  v_mov_b32 v207, 0
  s_cmp_eq_u32 s40, 0
  s_cbranch_scc1 L_AOUT
  s_mov_b32 s27, 0
L_APOLL:
  s_waitcnt vmcnt(0)
  v_cmp_ne_u32 vcc, s63, v143
  s_nop 1
  s_and_b64 vcc, vcc, s[46:47]
  s_cselect_b32 s40, 1, 0
  s_cbranch_scc0 L_AOK
  s_add_u32 s27, s27, 1
  s_cmp_gt_u32 s27, 40000
  s_cbranch_scc1 L_AOK
  s_mov_b64 exec, s[46:47]
  buffer_load_dword v143, v140, s[8:11], s41 offen sc1
  s_mov_b64 exec, -1
  s_branch L_APOLL
L_AOK:
  buffer_load_dwordx4 v[208:211], v3, s[8:11], s23 offen offset:0 sc1
  buffer_load_dwordx4 v[212:215], v3, s[8:11], s23 offen offset:1024 sc1
  buffer_load_dwordx4 v[144:147], v248, s[12:15], 0 offen offset:0 sc1
  buffer_load_dwordx4 v[148:151], v248, s[12:15], 0 offen offset:1024 sc1
  buffer_load_dwordx4 v[152:155], v248, s[12:15], 0 offen offset:2048 sc1
  buffer_load_dwordx4 v[156:159], v248, s[12:15], 0 offen offset:3072 sc1
L_AOUT:
  v_mov_b32 v14, 0x3e8b97f6
  v_mov_b32 v15, 0x3e8b97f6
  s_lshl_b32 s27, s3, 11
  s_add_u32 s27, s27, 147456
  v_add_u32 v12, s27, v3
  s_add_u32 s27, s3, 1
  s_and_b32 s27, s27, 3
  s_lshl_b32 s27, s27, 11
  s_add_u32 s27, s27, 147456
  v_add_u32 v136, s27, v3
  s_add_u32 s27, s3, 2
  s_and_b32 s27, s27, 3
  s_lshl_b32 s27, s27, 11
  s_add_u32 s27, s27, 147456
  v_add_u32 v137, s27, v3
  s_add_u32 s27, s3, 3
  s_and_b32 s27, s27, 3
  s_lshl_b32 s27, s27, 11
  s_add_u32 s27, s27, 147456
  v_add_u32 v138, s27, v3
  s_add_u32 s27, s3, 4
  s_and_b32 s27, s27, 3
  s_lshl_b32 s27, s27, 11
  s_add_u32 s27, s27, 147456
  v_add_u32 v139, s27, v3
  v_pk_mul_f32 v[112:113], v[112:113], v[14:15]
  v_pk_mul_f32 v[114:115], v[114:115], v[14:15]
  v_pk_mul_f32 v[116:117], v[116:117], v[14:15]
  v_pk_mul_f32 v[118:119], v[118:119], v[14:15]
  v_pk_mul_f32 v[120:121], v[120:121], v[14:15]
  v_pk_mul_f32 v[122:123], v[122:123], v[14:15]
  v_pk_mul_f32 v[124:125], v[124:125], v[14:15]
  v_pk_mul_f32 v[126:127], v[126:127], v[14:15]
  v_cvt_pk_bf16_f32 v16, v112, v113
  v_cvt_pk_bf16_f32 v17, v114, v115
  v_cvt_pk_bf16_f32 v18, v116, v117
  v_cvt_pk_bf16_f32 v19, v118, v119
  v_cvt_pk_bf16_f32 v20, v120, v121
  v_cvt_pk_bf16_f32 v21, v122, v123
  v_cvt_pk_bf16_f32 v22, v124, v125
  v_cvt_pk_bf16_f32 v23, v126, v127
  s_mov_b64 exec, s[28:29]
  v_mov_b32 v22, 0
  v_mov_b32 v23, 0
  s_mov_b64 exec, -1
  ds_write_b128 v12, v[16:19]
  s_waitcnt vmcnt(4)
  v_mfma_f32_32x32x16_bf16 v[216:231], v[208:211], v[16:19], 0
  v_mfma_f32_32x32x16_bf16 v[216:231], v[212:215], v[20:23], v[216:231]
  v_mov_b32 v140, 0
  v_mov_b32 v141, 0
  v_mov_b32 v142, 0
  v_mov_b32 v143, 0
  buffer_load_dwordx4 v[160:163], v249, s[12:15], 0 offen offset:0 sc1
  buffer_load_dwordx4 v[164:167], v249, s[12:15], 0 offen offset:1024 sc1
  buffer_load_dwordx4 v[168:171], v249, s[12:15], 0 offen offset:2048 sc1
  buffer_load_dwordx4 v[172:175], v249, s[12:15], 0 offen offset:3072 sc1
  s_nop 3
  v_max3_f32 v216, v216, v217, v218
  v_max3_f32 v216, v216, v219, v220
  v_max3_f32 v216, v216, v221, v222
  v_max3_f32 v216, v216, v223, v224
  v_max3_f32 v216, v216, v225, v226
  v_max3_f32 v216, v216, v227, v228
  v_max3_f32 v216, v216, v229, v230
  v_max_f32 v216, v216, v231
  s_mov_b64 exec, s[28:29]
  v_cvt_pk_bf16_f32 v22, -v216, 0
  s_mov_b64 exec, -1
  ds_write_b128 v12, v[20:23] offset:1024
  s_waitcnt lgkmcnt(0)
  s_barrier
  ds_read_b128 v[8:11], v136 offset:0
  ds_read_b128 v[12:15], v136 offset:1024
  ds_read_b128 v[16:19], v137 offset:0
  ds_read_b128 v[20:23], v137 offset:1024
  ds_read_b128 v[24:27], v138 offset:0
  ds_read_b128 v[28:31], v138 offset:1024
  ds_read_b128 v[32:35], v139 offset:0
  ds_read_b128 v[36:39], v139 offset:1024
  buffer_load_dwordx4 v[176:179], v250, s[12:15], 0 offen offset:0 sc1
  buffer_load_dwordx4 v[180:183], v250, s[12:15], 0 offen offset:1024 sc1
  buffer_load_dwordx4 v[184:187], v250, s[12:15], 0 offen offset:2048 sc1
  buffer_load_dwordx4 v[188:191], v250, s[12:15], 0 offen offset:3072 sc1
  buffer_load_dwordx4 v[192:195], v251, s[12:15], 0 offen offset:0 sc1
  buffer_load_dwordx4 v[196:199], v251, s[12:15], 0 offen offset:1024 sc1
  v_mov_b32 v208, 155648
  s_waitcnt lgkmcnt(0)
L_MAIN:
  s_waitcnt vmcnt(10)
  s_mov_b32 s30, 16384
  s_mov_b32 s31, 0
  v_mfma_f32_32x32x16_bf16 v[104:119], v[144:147], v[8:11], 0
  v_mfma_f32_32x32x16_bf16 v[104:119], v[148:151], v[12:15], v[104:119]
  s_nop 7
  s_nop 3
  v_mfma_f32_32x32x16_bf16 v[120:135], v[144:147], v[16:19], 0
  v_exp_f32 v104, v104
  v_exp_f32 v105, v105
  v_exp_f32 v106, v106
  v_exp_f32 v107, v107
  v_cvt_pk_bf16_f32 v136, v104, v105
  v_cvt_pk_bf16_f32 v137, v106, v107
  v_mfma_f32_32x32x16_bf16 v[88:103], v[204:207], v[140:143], v[88:103]
  v_exp_f32 v108, v108
  v_exp_f32 v109, v109
  v_exp_f32 v110, v110
  v_exp_f32 v111, v111
  v_cvt_pk_bf16_f32 v138, v108, v109
  v_cvt_pk_bf16_f32 v139, v110, v111
  v_mfma_f32_32x32x16_bf16 v[120:135], v[148:151], v[20:23], v[120:135]
  v_exp_f32 v112, v112
  v_exp_f32 v113, v113
  v_exp_f32 v114, v114
  v_exp_f32 v115, v115
  v_cvt_pk_bf16_f32 v140, v112, v113
  v_cvt_pk_bf16_f32 v141, v114, v115
  v_mfma_f32_32x32x16_bf16 v[40:55], v[152:155], v[136:139], v[40:55]
  v_exp_f32 v116, v116
  v_exp_f32 v117, v117
  v_exp_f32 v118, v118
  v_exp_f32 v119, v119
  v_cvt_pk_bf16_f32 v142, v116, v117
  v_cvt_pk_bf16_f32 v143, v118, v119
  v_mfma_f32_32x32x16_bf16 v[104:119], v[144:147], v[24:27], 0
  buffer_load_dwordx4 v[200:203], v251, s[12:15], s31 offen offset:2048 sc1
  v_exp_f32 v120, v120
  v_exp_f32 v121, v121
  v_exp_f32 v122, v122
  v_exp_f32 v123, v123
  v_cvt_pk_bf16_f32 v136, v120, v121
  v_cvt_pk_bf16_f32 v137, v122, v123
  v_mfma_f32_32x32x16_bf16 v[40:55], v[156:159], v[140:143], v[40:55]
  buffer_load_dwordx4 v[204:207], v251, s[12:15], s31 offen offset:3072 sc1
  v_exp_f32 v124, v124
  v_exp_f32 v125, v125
  v_exp_f32 v126, v126
  v_exp_f32 v127, v127
  v_cvt_pk_bf16_f32 v138, v124, v125
  v_cvt_pk_bf16_f32 v139, v126, v127
  v_mfma_f32_32x32x16_bf16 v[104:119], v[148:151], v[28:31], v[104:119]
  v_exp_f32 v128, v128
  v_exp_f32 v129, v129
  v_exp_f32 v130, v130
  v_exp_f32 v131, v131
  v_cvt_pk_bf16_f32 v140, v128, v129
  v_cvt_pk_bf16_f32 v141, v130, v131
  v_mfma_f32_32x32x16_bf16 v[56:71], v[152:155], v[136:139], v[56:71]
  v_exp_f32 v132, v132
  v_exp_f32 v133, v133
  v_exp_f32 v134, v134
  v_exp_f32 v135, v135
  v_cvt_pk_bf16_f32 v142, v132, v133
  v_cvt_pk_bf16_f32 v143, v134, v135
  v_mfma_f32_32x32x16_bf16 v[120:135], v[144:147], v[32:35], 0
  v_exp_f32 v104, v104
  v_exp_f32 v105, v105
  v_exp_f32 v106, v106
  v_exp_f32 v107, v107
  v_cvt_pk_bf16_f32 v136, v104, v105
  v_cvt_pk_bf16_f32 v137, v106, v107
  v_mfma_f32_32x32x16_bf16 v[56:71], v[156:159], v[140:143], v[56:71]
  v_exp_f32 v108, v108
  v_exp_f32 v109, v109
  v_exp_f32 v110, v110
  v_exp_f32 v111, v111
  v_cvt_pk_bf16_f32 v138, v108, v109
  v_cvt_pk_bf16_f32 v139, v110, v111
  v_mfma_f32_32x32x16_bf16 v[120:135], v[148:151], v[36:39], v[120:135]
  v_exp_f32 v112, v112
  v_exp_f32 v113, v113
  v_exp_f32 v114, v114
  v_exp_f32 v115, v115
  v_cvt_pk_bf16_f32 v140, v112, v113
  v_cvt_pk_bf16_f32 v141, v114, v115
  v_mfma_f32_32x32x16_bf16 v[72:87], v[152:155], v[136:139], v[72:87]
  s_waitcnt vmcnt(8)
  v_exp_f32 v116, v116
  v_exp_f32 v117, v117
  v_exp_f32 v118, v118
  v_exp_f32 v119, v119
  v_cvt_pk_bf16_f32 v142, v116, v117
  v_cvt_pk_bf16_f32 v143, v118, v119
  v_mfma_f32_32x32x16_bf16 v[104:119], v[160:163], v[8:11], 0
  buffer_load_dwordx4 v[144:147], v248, s[12:15], s30 offen offset:0 sc1
  v_exp_f32 v120, v120
  v_exp_f32 v121, v121
  v_exp_f32 v122, v122
  v_exp_f32 v123, v123
  v_cvt_pk_bf16_f32 v136, v120, v121
  v_cvt_pk_bf16_f32 v137, v122, v123
  v_mfma_f32_32x32x16_bf16 v[72:87], v[156:159], v[140:143], v[72:87]
  buffer_load_dwordx4 v[148:151], v248, s[12:15], s30 offen offset:1024 sc1
  v_exp_f32 v124, v124
  v_exp_f32 v125, v125
  v_exp_f32 v126, v126
  v_exp_f32 v127, v127
  v_cvt_pk_bf16_f32 v138, v124, v125
  v_cvt_pk_bf16_f32 v139, v126, v127
  v_mfma_f32_32x32x16_bf16 v[104:119], v[164:167], v[12:15], v[104:119]
  v_exp_f32 v128, v128
  v_exp_f32 v129, v129
  v_exp_f32 v130, v130
  v_exp_f32 v131, v131
  v_cvt_pk_bf16_f32 v140, v128, v129
  v_cvt_pk_bf16_f32 v141, v130, v131
  v_mfma_f32_32x32x16_bf16 v[88:103], v[152:155], v[136:139], v[88:103]
  v_exp_f32 v132, v132
  v_exp_f32 v133, v133
  v_exp_f32 v134, v134
  v_exp_f32 v135, v135
  v_cvt_pk_bf16_f32 v142, v132, v133
  v_cvt_pk_bf16_f32 v143, v134, v135
  v_mfma_f32_32x32x16_bf16 v[120:135], v[160:163], v[16:19], 0
  v_exp_f32 v104, v104
  v_exp_f32 v105, v105
  v_exp_f32 v106, v106
  v_exp_f32 v107, v107
  v_cvt_pk_bf16_f32 v136, v104, v105
  v_cvt_pk_bf16_f32 v137, v106, v107
  v_mfma_f32_32x32x16_bf16 v[88:103], v[156:159], v[140:143], v[88:103]
  v_exp_f32 v108, v108
  v_exp_f32 v109, v109
  v_exp_f32 v110, v110
  v_exp_f32 v111, v111
  v_cvt_pk_bf16_f32 v138, v108, v109
  v_cvt_pk_bf16_f32 v139, v110, v111
  v_mfma_f32_32x32x16_bf16 v[120:135], v[164:167], v[20:23], v[120:135]
  v_exp_f32 v112, v112
  v_exp_f32 v113, v113
  v_exp_f32 v114, v114
  v_exp_f32 v115, v115
  v_cvt_pk_bf16_f32 v140, v112, v113
  v_cvt_pk_bf16_f32 v141, v114, v115
  v_mfma_f32_32x32x16_bf16 v[40:55], v[168:171], v[136:139], v[40:55]
  v_exp_f32 v116, v116
  v_exp_f32 v117, v117
  v_exp_f32 v118, v118
  v_exp_f32 v119, v119
  v_cvt_pk_bf16_f32 v142, v116, v117
  v_cvt_pk_bf16_f32 v143, v118, v119
  v_mfma_f32_32x32x16_bf16 v[104:119], v[160:163], v[24:27], 0
  buffer_load_dwordx4 v[152:155], v248, s[12:15], s30 offen offset:2048 sc1
  v_exp_f32 v120, v120
  v_exp_f32 v121, v121
  v_exp_f32 v122, v122
  v_exp_f32 v123, v123
  v_cvt_pk_bf16_f32 v136, v120, v121
  v_cvt_pk_bf16_f32 v137, v122, v123
  v_mfma_f32_32x32x16_bf16 v[40:55], v[172:175], v[140:143], v[40:55]
  buffer_load_dwordx4 v[156:159], v248, s[12:15], s30 offen offset:3072 sc1
  v_exp_f32 v124, v124
  v_exp_f32 v125, v125
  v_exp_f32 v126, v126
  v_exp_f32 v127, v127
  v_cvt_pk_bf16_f32 v138, v124, v125
  v_cvt_pk_bf16_f32 v139, v126, v127
  v_mfma_f32_32x32x16_bf16 v[104:119], v[164:167], v[28:31], v[104:119]
  v_exp_f32 v128, v128
  v_exp_f32 v129, v129
  v_exp_f32 v130, v130
  v_exp_f32 v131, v131
  v_cvt_pk_bf16_f32 v140, v128, v129
  v_cvt_pk_bf16_f32 v141, v130, v131
  v_mfma_f32_32x32x16_bf16 v[56:71], v[168:171], v[136:139], v[56:71]
  v_exp_f32 v132, v132
  v_exp_f32 v133, v133
  v_exp_f32 v134, v134
  v_exp_f32 v135, v135
  v_cvt_pk_bf16_f32 v142, v132, v133
  v_cvt_pk_bf16_f32 v143, v134, v135
  v_mfma_f32_32x32x16_bf16 v[120:135], v[160:163], v[32:35], 0
  v_exp_f32 v104, v104
  v_exp_f32 v105, v105
  v_exp_f32 v106, v106
  v_exp_f32 v107, v107
  v_cvt_pk_bf16_f32 v136, v104, v105
  v_cvt_pk_bf16_f32 v137, v106, v107
  v_mfma_f32_32x32x16_bf16 v[56:71], v[172:175], v[140:143], v[56:71]
  v_exp_f32 v108, v108
  v_exp_f32 v109, v109
  v_exp_f32 v110, v110
  v_exp_f32 v111, v111
  v_cvt_pk_bf16_f32 v138, v108, v109
  v_cvt_pk_bf16_f32 v139, v110, v111
  v_mfma_f32_32x32x16_bf16 v[120:135], v[164:167], v[36:39], v[120:135]
  v_exp_f32 v112, v112
  v_exp_f32 v113, v113
  v_exp_f32 v114, v114
  v_exp_f32 v115, v115
  v_cvt_pk_bf16_f32 v140, v112, v113
  v_cvt_pk_bf16_f32 v141, v114, v115
  v_mfma_f32_32x32x16_bf16 v[72:87], v[168:171], v[136:139], v[72:87]
  s_waitcnt vmcnt(8)
  v_exp_f32 v116, v116
  v_exp_f32 v117, v117
  v_exp_f32 v118, v118
  v_exp_f32 v119, v119
  v_cvt_pk_bf16_f32 v142, v116, v117
  v_cvt_pk_bf16_f32 v143, v118, v119
  v_mfma_f32_32x32x16_bf16 v[104:119], v[176:179], v[8:11], 0
  buffer_load_dwordx4 v[160:163], v249, s[12:15], s30 offen offset:0 sc1
  v_exp_f32 v120, v120
  v_exp_f32 v121, v121
  v_exp_f32 v122, v122
  v_exp_f32 v123, v123
  v_cvt_pk_bf16_f32 v136, v120, v121
  v_cvt_pk_bf16_f32 v137, v122, v123
  v_mfma_f32_32x32x16_bf16 v[72:87], v[172:175], v[140:143], v[72:87]
  buffer_load_dwordx4 v[164:167], v249, s[12:15], s30 offen offset:1024 sc1
  v_exp_f32 v124, v124
  v_exp_f32 v125, v125
  v_exp_f32 v126, v126
  v_exp_f32 v127, v127
  v_cvt_pk_bf16_f32 v138, v124, v125
  v_cvt_pk_bf16_f32 v139, v126, v127
  v_mfma_f32_32x32x16_bf16 v[104:119], v[180:183], v[12:15], v[104:119]
  v_exp_f32 v128, v128
  v_exp_f32 v129, v129
  v_exp_f32 v130, v130
  v_exp_f32 v131, v131
  v_cvt_pk_bf16_f32 v140, v128, v129
  v_cvt_pk_bf16_f32 v141, v130, v131
  v_mfma_f32_32x32x16_bf16 v[88:103], v[168:171], v[136:139], v[88:103]
  v_exp_f32 v132, v132
  v_exp_f32 v133, v133
  v_exp_f32 v134, v134
  v_exp_f32 v135, v135
  v_cvt_pk_bf16_f32 v142, v132, v133
  v_cvt_pk_bf16_f32 v143, v134, v135
  v_mfma_f32_32x32x16_bf16 v[120:135], v[176:179], v[16:19], 0
  v_exp_f32 v104, v104
  v_exp_f32 v105, v105
  v_exp_f32 v106, v106
  v_exp_f32 v107, v107
  v_cvt_pk_bf16_f32 v136, v104, v105
  v_cvt_pk_bf16_f32 v137, v106, v107
  v_mfma_f32_32x32x16_bf16 v[88:103], v[172:175], v[140:143], v[88:103]
  v_exp_f32 v108, v108
  v_exp_f32 v109, v109
  v_exp_f32 v110, v110
  v_exp_f32 v111, v111
  v_cvt_pk_bf16_f32 v138, v108, v109
  v_cvt_pk_bf16_f32 v139, v110, v111
  v_mfma_f32_32x32x16_bf16 v[120:135], v[180:183], v[20:23], v[120:135]
  v_exp_f32 v112, v112
  v_exp_f32 v113, v113
  v_exp_f32 v114, v114
  v_exp_f32 v115, v115
  v_cvt_pk_bf16_f32 v140, v112, v113
  v_cvt_pk_bf16_f32 v141, v114, v115
  v_mfma_f32_32x32x16_bf16 v[40:55], v[184:187], v[136:139], v[40:55]
  v_exp_f32 v116, v116
  v_exp_f32 v117, v117
  v_exp_f32 v118, v118
  v_exp_f32 v119, v119
  v_cvt_pk_bf16_f32 v142, v116, v117
  v_cvt_pk_bf16_f32 v143, v118, v119
  v_mfma_f32_32x32x16_bf16 v[104:119], v[176:179], v[24:27], 0
  buffer_load_dwordx4 v[168:171], v249, s[12:15], s30 offen offset:2048 sc1
  v_exp_f32 v120, v120
  v_exp_f32 v121, v121
  v_exp_f32 v122, v122
  v_exp_f32 v123, v123
  v_cvt_pk_bf16_f32 v136, v120, v121
  v_cvt_pk_bf16_f32 v137, v122, v123
  v_mfma_f32_32x32x16_bf16 v[40:55], v[188:191], v[140:143], v[40:55]
  buffer_load_dwordx4 v[172:175], v249, s[12:15], s30 offen offset:3072 sc1
  v_exp_f32 v124, v124
  v_exp_f32 v125, v125
  v_exp_f32 v126, v126
  v_exp_f32 v127, v127
  v_cvt_pk_bf16_f32 v138, v124, v125
  v_cvt_pk_bf16_f32 v139, v126, v127
  v_mfma_f32_32x32x16_bf16 v[104:119], v[180:183], v[28:31], v[104:119]
  v_exp_f32 v128, v128
  v_exp_f32 v129, v129
  v_exp_f32 v130, v130
  v_exp_f32 v131, v131
  v_cvt_pk_bf16_f32 v140, v128, v129
  v_cvt_pk_bf16_f32 v141, v130, v131
  v_mfma_f32_32x32x16_bf16 v[56:71], v[184:187], v[136:139], v[56:71]
  v_exp_f32 v132, v132
  v_exp_f32 v133, v133
  v_exp_f32 v134, v134
  v_exp_f32 v135, v135
  v_cvt_pk_bf16_f32 v142, v132, v133
  v_cvt_pk_bf16_f32 v143, v134, v135
  v_mfma_f32_32x32x16_bf16 v[120:135], v[176:179], v[32:35], 0
  v_exp_f32 v104, v104
  v_exp_f32 v105, v105
  v_exp_f32 v106, v106
  v_exp_f32 v107, v107
  v_cvt_pk_bf16_f32 v136, v104, v105
  v_cvt_pk_bf16_f32 v137, v106, v107
  v_mfma_f32_32x32x16_bf16 v[56:71], v[188:191], v[140:143], v[56:71]
  v_exp_f32 v108, v108
  v_exp_f32 v109, v109
  v_exp_f32 v110, v110
  v_exp_f32 v111, v111
  v_cvt_pk_bf16_f32 v138, v108, v109
  v_cvt_pk_bf16_f32 v139, v110, v111
  v_mfma_f32_32x32x16_bf16 v[120:135], v[180:183], v[36:39], v[120:135]
  v_exp_f32 v112, v112
  v_exp_f32 v113, v113
  v_exp_f32 v114, v114
  v_exp_f32 v115, v115
  v_cvt_pk_bf16_f32 v140, v112, v113
  v_cvt_pk_bf16_f32 v141, v114, v115
  v_mfma_f32_32x32x16_bf16 v[72:87], v[184:187], v[136:139], v[72:87]
  s_waitcnt vmcnt(8)
  v_exp_f32 v116, v116
  v_exp_f32 v117, v117
  v_exp_f32 v118, v118
  v_exp_f32 v119, v119
  v_cvt_pk_bf16_f32 v142, v116, v117
  v_cvt_pk_bf16_f32 v143, v118, v119
  v_mfma_f32_32x32x16_bf16 v[104:119], v[192:195], v[8:11], 0
  buffer_load_dwordx4 v[176:179], v250, s[12:15], s30 offen offset:0 sc1
  v_exp_f32 v120, v120
  v_exp_f32 v121, v121
  v_exp_f32 v122, v122
  v_exp_f32 v123, v123
  v_cvt_pk_bf16_f32 v136, v120, v121
  v_cvt_pk_bf16_f32 v137, v122, v123
  v_mfma_f32_32x32x16_bf16 v[72:87], v[188:191], v[140:143], v[72:87]
  buffer_load_dwordx4 v[180:183], v250, s[12:15], s30 offen offset:1024 sc1
  v_exp_f32 v124, v124
  v_exp_f32 v125, v125
  v_exp_f32 v126, v126
  v_exp_f32 v127, v127
  v_cvt_pk_bf16_f32 v138, v124, v125
  v_cvt_pk_bf16_f32 v139, v126, v127
  v_mfma_f32_32x32x16_bf16 v[104:119], v[196:199], v[12:15], v[104:119]
  v_exp_f32 v128, v128
  v_exp_f32 v129, v129
  v_exp_f32 v130, v130
  v_exp_f32 v131, v131
  v_cvt_pk_bf16_f32 v140, v128, v129
  v_cvt_pk_bf16_f32 v141, v130, v131
  v_mfma_f32_32x32x16_bf16 v[88:103], v[184:187], v[136:139], v[88:103]
  v_exp_f32 v132, v132
  v_exp_f32 v133, v133
  v_exp_f32 v134, v134
  v_exp_f32 v135, v135
  v_cvt_pk_bf16_f32 v142, v132, v133
  v_cvt_pk_bf16_f32 v143, v134, v135
  v_mfma_f32_32x32x16_bf16 v[120:135], v[192:195], v[16:19], 0
  ds_read_b32 v209, v208 offset:8
  v_exp_f32 v104, v104
  v_exp_f32 v105, v105
  v_exp_f32 v106, v106
  v_exp_f32 v107, v107
  v_cvt_pk_bf16_f32 v136, v104, v105
  v_cvt_pk_bf16_f32 v137, v106, v107
  v_mfma_f32_32x32x16_bf16 v[88:103], v[188:191], v[140:143], v[88:103]
  v_exp_f32 v108, v108
  v_exp_f32 v109, v109
  v_exp_f32 v110, v110
  v_exp_f32 v111, v111
  v_cvt_pk_bf16_f32 v138, v108, v109
  v_cvt_pk_bf16_f32 v139, v110, v111
  v_mfma_f32_32x32x16_bf16 v[120:135], v[196:199], v[20:23], v[120:135]
  v_exp_f32 v112, v112
  v_exp_f32 v113, v113
  v_exp_f32 v114, v114
  v_exp_f32 v115, v115
  v_cvt_pk_bf16_f32 v140, v112, v113
  v_cvt_pk_bf16_f32 v141, v114, v115
  v_mfma_f32_32x32x16_bf16 v[40:55], v[200:203], v[136:139], v[40:55]
  v_exp_f32 v116, v116
  v_exp_f32 v117, v117
  v_exp_f32 v118, v118
  v_exp_f32 v119, v119
  v_cvt_pk_bf16_f32 v142, v116, v117
  v_cvt_pk_bf16_f32 v143, v118, v119
  v_mfma_f32_32x32x16_bf16 v[104:119], v[192:195], v[24:27], 0
  buffer_load_dwordx4 v[184:187], v250, s[12:15], s30 offen offset:2048 sc1
  v_exp_f32 v120, v120
  v_exp_f32 v121, v121
  v_exp_f32 v122, v122
  v_exp_f32 v123, v123
  v_cvt_pk_bf16_f32 v136, v120, v121
  v_cvt_pk_bf16_f32 v137, v122, v123
  v_mfma_f32_32x32x16_bf16 v[40:55], v[204:207], v[140:143], v[40:55]
  buffer_load_dwordx4 v[188:191], v250, s[12:15], s30 offen offset:3072 sc1
  v_exp_f32 v124, v124
  v_exp_f32 v125, v125
  v_exp_f32 v126, v126
  v_exp_f32 v127, v127
  v_cvt_pk_bf16_f32 v138, v124, v125
  v_cvt_pk_bf16_f32 v139, v126, v127
  v_mfma_f32_32x32x16_bf16 v[104:119], v[196:199], v[28:31], v[104:119]
  v_exp_f32 v128, v128
  v_exp_f32 v129, v129
  v_exp_f32 v130, v130
  v_exp_f32 v131, v131
  v_cvt_pk_bf16_f32 v140, v128, v129
  v_cvt_pk_bf16_f32 v141, v130, v131
  v_mfma_f32_32x32x16_bf16 v[56:71], v[200:203], v[136:139], v[56:71]
  v_exp_f32 v132, v132
  v_exp_f32 v133, v133
  v_exp_f32 v134, v134
  v_exp_f32 v135, v135
  v_cvt_pk_bf16_f32 v142, v132, v133
  v_cvt_pk_bf16_f32 v143, v134, v135
  v_mfma_f32_32x32x16_bf16 v[120:135], v[192:195], v[32:35], 0
  s_waitcnt lgkmcnt(0)
  v_exp_f32 v104, v104
  v_exp_f32 v105, v105
  v_exp_f32 v106, v106
  v_exp_f32 v107, v107
  v_cvt_pk_bf16_f32 v136, v104, v105
  v_cvt_pk_bf16_f32 v137, v106, v107
  v_mfma_f32_32x32x16_bf16 v[56:71], v[204:207], v[140:143], v[56:71]
  v_readfirstlane_b32 s40, v209
  v_exp_f32 v108, v108
  v_exp_f32 v109, v109
  v_exp_f32 v110, v110
  v_exp_f32 v111, v111
  v_cvt_pk_bf16_f32 v138, v108, v109
  v_cvt_pk_bf16_f32 v139, v110, v111
  v_mfma_f32_32x32x16_bf16 v[120:135], v[196:199], v[36:39], v[120:135]
  v_exp_f32 v112, v112
  v_exp_f32 v113, v113
  v_exp_f32 v114, v114
  v_exp_f32 v115, v115
  v_cvt_pk_bf16_f32 v140, v112, v113
  v_cvt_pk_bf16_f32 v141, v114, v115
  v_mfma_f32_32x32x16_bf16 v[72:87], v[200:203], v[136:139], v[72:87]
  s_waitcnt vmcnt(8)
  v_exp_f32 v116, v116
  v_exp_f32 v117, v117
  v_exp_f32 v118, v118
  v_exp_f32 v119, v119
  v_cvt_pk_bf16_f32 v142, v116, v117
  v_cvt_pk_bf16_f32 v143, v118, v119
  v_mfma_f32_32x32x16_bf16 v[104:119], v[144:147], v[8:11], 0
  buffer_load_dwordx4 v[192:195], v251, s[12:15], s30 offen offset:0 sc1
  v_exp_f32 v120, v120
  v_exp_f32 v121, v121
  v_exp_f32 v122, v122
  v_exp_f32 v123, v123
  v_cvt_pk_bf16_f32 v136, v120, v121
  v_cvt_pk_bf16_f32 v137, v122, v123
  v_mfma_f32_32x32x16_bf16 v[72:87], v[204:207], v[140:143], v[72:87]
  buffer_load_dwordx4 v[196:199], v251, s[12:15], s30 offen offset:1024 sc1
  v_exp_f32 v124, v124
  v_exp_f32 v125, v125
  v_exp_f32 v126, v126
  v_exp_f32 v127, v127
  v_cvt_pk_bf16_f32 v138, v124, v125
  v_cvt_pk_bf16_f32 v139, v126, v127
  v_mfma_f32_32x32x16_bf16 v[104:119], v[148:151], v[12:15], v[104:119]
  v_exp_f32 v128, v128
  v_exp_f32 v129, v129
  v_exp_f32 v130, v130
  v_exp_f32 v131, v131
  v_cvt_pk_bf16_f32 v140, v128, v129
  v_cvt_pk_bf16_f32 v141, v130, v131
  v_mfma_f32_32x32x16_bf16 v[88:103], v[200:203], v[136:139], v[88:103]
  v_exp_f32 v132, v132
  s_add_u32 s31, s31, 16384
  v_exp_f32 v133, v133
  s_add_u32 s30, s30, 16384
  v_exp_f32 v134, v134
  s_cmp_lt_u32 s31, 49152
  v_exp_f32 v135, v135
  v_cvt_pk_bf16_f32 v142, v132, v133
  v_cvt_pk_bf16_f32 v143, v134, v135
  s_cmp_lg_u32 s40, 0
  s_cbranch_scc1 L_BOK
  s_mov_b32 s27, 0
L_BWAIT:
  ds_read_b32 v209, v208 offset:8
  s_waitcnt lgkmcnt(0)
  v_readfirstlane_b32 s40, v209
  s_add_u32 s27, s27, 1
  s_cmp_gt_u32 s27, 2560000
  s_cbranch_scc1 L_BOK
  s_cmp_eq_u32 s40, 0
  s_cbranch_scc1 L_BWAIT
L_BOK:
  v_mfma_f32_32x32x16_bf16 v[120:135], v[144:147], v[16:19], 0
  v_exp_f32 v104, v104
  v_exp_f32 v105, v105
  v_exp_f32 v106, v106
  v_exp_f32 v107, v107
  v_cvt_pk_bf16_f32 v136, v104, v105
  v_cvt_pk_bf16_f32 v137, v106, v107
  v_mfma_f32_32x32x16_bf16 v[88:103], v[204:207], v[140:143], v[88:103]
  v_exp_f32 v108, v108
  v_exp_f32 v109, v109
  v_exp_f32 v110, v110
  v_exp_f32 v111, v111
  v_cvt_pk_bf16_f32 v138, v108, v109
  v_cvt_pk_bf16_f32 v139, v110, v111
  v_mfma_f32_32x32x16_bf16 v[120:135], v[148:151], v[20:23], v[120:135]
  v_exp_f32 v112, v112
  v_exp_f32 v113, v113
  v_exp_f32 v114, v114
  v_exp_f32 v115, v115
  v_cvt_pk_bf16_f32 v140, v112, v113
  v_cvt_pk_bf16_f32 v141, v114, v115
  v_mfma_f32_32x32x16_bf16 v[40:55], v[152:155], v[136:139], v[40:55]
  v_exp_f32 v116, v116
  v_exp_f32 v117, v117
  v_exp_f32 v118, v118
  v_exp_f32 v119, v119
  v_cvt_pk_bf16_f32 v142, v116, v117
  v_cvt_pk_bf16_f32 v143, v118, v119
  v_mfma_f32_32x32x16_bf16 v[104:119], v[144:147], v[24:27], 0
  buffer_load_dwordx4 v[200:203], v251, s[12:15], s31 offen offset:2048 sc1
  v_exp_f32 v120, v120
  v_exp_f32 v121, v121
  v_exp_f32 v122, v122
  v_exp_f32 v123, v123
  v_cvt_pk_bf16_f32 v136, v120, v121
  v_cvt_pk_bf16_f32 v137, v122, v123
  v_mfma_f32_32x32x16_bf16 v[40:55], v[156:159], v[140:143], v[40:55]
  buffer_load_dwordx4 v[204:207], v251, s[12:15], s31 offen offset:3072 sc1
  v_exp_f32 v124, v124
  v_exp_f32 v125, v125
  v_exp_f32 v126, v126
  v_exp_f32 v127, v127
  v_cvt_pk_bf16_f32 v138, v124, v125
  v_cvt_pk_bf16_f32 v139, v126, v127
  v_mfma_f32_32x32x16_bf16 v[104:119], v[148:151], v[28:31], v[104:119]
  v_exp_f32 v128, v128
  v_exp_f32 v129, v129
  v_exp_f32 v130, v130
  v_exp_f32 v131, v131
  v_cvt_pk_bf16_f32 v140, v128, v129
  v_cvt_pk_bf16_f32 v141, v130, v131
  v_mfma_f32_32x32x16_bf16 v[56:71], v[152:155], v[136:139], v[56:71]
  v_exp_f32 v132, v132
  v_exp_f32 v133, v133
  v_exp_f32 v134, v134
  v_exp_f32 v135, v135
  v_cvt_pk_bf16_f32 v142, v132, v133
  v_cvt_pk_bf16_f32 v143, v134, v135
  v_mfma_f32_32x32x16_bf16 v[120:135], v[144:147], v[32:35], 0
  v_exp_f32 v104, v104
  v_exp_f32 v105, v105
  v_exp_f32 v106, v106
  v_exp_f32 v107, v107
  v_cvt_pk_bf16_f32 v136, v104, v105
  v_cvt_pk_bf16_f32 v137, v106, v107
  v_mfma_f32_32x32x16_bf16 v[56:71], v[156:159], v[140:143], v[56:71]
  v_exp_f32 v108, v108
  v_exp_f32 v109, v109
  v_exp_f32 v110, v110
  v_exp_f32 v111, v111
  v_cvt_pk_bf16_f32 v138, v108, v109
  v_cvt_pk_bf16_f32 v139, v110, v111
  v_mfma_f32_32x32x16_bf16 v[120:135], v[148:151], v[36:39], v[120:135]
  v_exp_f32 v112, v112
  v_exp_f32 v113, v113
  v_exp_f32 v114, v114
  v_exp_f32 v115, v115
  v_cvt_pk_bf16_f32 v140, v112, v113
  v_cvt_pk_bf16_f32 v141, v114, v115
  v_mfma_f32_32x32x16_bf16 v[72:87], v[152:155], v[136:139], v[72:87]
  s_waitcnt vmcnt(8)
  v_exp_f32 v116, v116
  v_exp_f32 v117, v117
  v_exp_f32 v118, v118
  v_exp_f32 v119, v119
  v_cvt_pk_bf16_f32 v142, v116, v117
  v_cvt_pk_bf16_f32 v143, v118, v119
  v_mfma_f32_32x32x16_bf16 v[104:119], v[160:163], v[8:11], 0
  buffer_load_dwordx4 v[144:147], v248, s[12:15], s30 offen offset:0 sc1
  v_exp_f32 v120, v120
  v_exp_f32 v121, v121
  v_exp_f32 v122, v122
  v_exp_f32 v123, v123
  v_cvt_pk_bf16_f32 v136, v120, v121
  v_cvt_pk_bf16_f32 v137, v122, v123
  v_mfma_f32_32x32x16_bf16 v[72:87], v[156:159], v[140:143], v[72:87]
  buffer_load_dwordx4 v[148:151], v248, s[12:15], s30 offen offset:1024 sc1
  v_exp_f32 v124, v124
  v_exp_f32 v125, v125
  v_exp_f32 v126, v126
  v_exp_f32 v127, v127
  v_cvt_pk_bf16_f32 v138, v124, v125
  v_cvt_pk_bf16_f32 v139, v126, v127
  v_mfma_f32_32x32x16_bf16 v[104:119], v[164:167], v[12:15], v[104:119]
  v_exp_f32 v128, v128
  v_exp_f32 v129, v129
  v_exp_f32 v130, v130
  v_exp_f32 v131, v131
  v_cvt_pk_bf16_f32 v140, v128, v129
  v_cvt_pk_bf16_f32 v141, v130, v131
  v_mfma_f32_32x32x16_bf16 v[88:103], v[152:155], v[136:139], v[88:103]
  v_exp_f32 v132, v132
  v_exp_f32 v133, v133
  v_exp_f32 v134, v134
  v_exp_f32 v135, v135
  v_cvt_pk_bf16_f32 v142, v132, v133
  v_cvt_pk_bf16_f32 v143, v134, v135
  v_mfma_f32_32x32x16_bf16 v[120:135], v[160:163], v[16:19], 0
  v_exp_f32 v104, v104
  v_exp_f32 v105, v105
  v_exp_f32 v106, v106
  v_exp_f32 v107, v107
  v_cvt_pk_bf16_f32 v136, v104, v105
  v_cvt_pk_bf16_f32 v137, v106, v107
  v_mfma_f32_32x32x16_bf16 v[88:103], v[156:159], v[140:143], v[88:103]
  v_exp_f32 v108, v108
  v_exp_f32 v109, v109
  v_exp_f32 v110, v110
  v_exp_f32 v111, v111
  v_cvt_pk_bf16_f32 v138, v108, v109
  v_cvt_pk_bf16_f32 v139, v110, v111
  v_mfma_f32_32x32x16_bf16 v[120:135], v[164:167], v[20:23], v[120:135]
  v_exp_f32 v112, v112
  v_exp_f32 v113, v113
  v_exp_f32 v114, v114
  v_exp_f32 v115, v115
  v_cvt_pk_bf16_f32 v140, v112, v113
  v_cvt_pk_bf16_f32 v141, v114, v115
  v_mfma_f32_32x32x16_bf16 v[40:55], v[168:171], v[136:139], v[40:55]
  v_exp_f32 v116, v116
  v_exp_f32 v117, v117
  v_exp_f32 v118, v118
  v_exp_f32 v119, v119
  v_cvt_pk_bf16_f32 v142, v116, v117
  v_cvt_pk_bf16_f32 v143, v118, v119
  v_mfma_f32_32x32x16_bf16 v[104:119], v[160:163], v[24:27], 0
  buffer_load_dwordx4 v[152:155], v248, s[12:15], s30 offen offset:2048 sc1
  v_exp_f32 v120, v120
  v_exp_f32 v121, v121
  v_exp_f32 v122, v122
  v_exp_f32 v123, v123
  v_cvt_pk_bf16_f32 v136, v120, v121
  v_cvt_pk_bf16_f32 v137, v122, v123
  v_mfma_f32_32x32x16_bf16 v[40:55], v[172:175], v[140:143], v[40:55]
  buffer_load_dwordx4 v[156:159], v248, s[12:15], s30 offen offset:3072 sc1
  v_exp_f32 v124, v124
  v_exp_f32 v125, v125
  v_exp_f32 v126, v126
  v_exp_f32 v127, v127
  v_cvt_pk_bf16_f32 v138, v124, v125
  v_cvt_pk_bf16_f32 v139, v126, v127
  v_mfma_f32_32x32x16_bf16 v[104:119], v[164:167], v[28:31], v[104:119]
  v_exp_f32 v128, v128
  v_exp_f32 v129, v129
  v_exp_f32 v130, v130
  v_exp_f32 v131, v131
  v_cvt_pk_bf16_f32 v140, v128, v129
  v_cvt_pk_bf16_f32 v141, v130, v131
  v_mfma_f32_32x32x16_bf16 v[56:71], v[168:171], v[136:139], v[56:71]
  v_exp_f32 v132, v132
  v_exp_f32 v133, v133
  v_exp_f32 v134, v134
  v_exp_f32 v135, v135
  v_cvt_pk_bf16_f32 v142, v132, v133
  v_cvt_pk_bf16_f32 v143, v134, v135
  v_mfma_f32_32x32x16_bf16 v[120:135], v[160:163], v[32:35], 0
  v_exp_f32 v104, v104
  v_exp_f32 v105, v105
  v_exp_f32 v106, v106
  v_exp_f32 v107, v107
  v_cvt_pk_bf16_f32 v136, v104, v105
  v_cvt_pk_bf16_f32 v137, v106, v107
  v_mfma_f32_32x32x16_bf16 v[56:71], v[172:175], v[140:143], v[56:71]
  v_exp_f32 v108, v108
  v_exp_f32 v109, v109
  v_exp_f32 v110, v110
  v_exp_f32 v111, v111
  v_cvt_pk_bf16_f32 v138, v108, v109
  v_cvt_pk_bf16_f32 v139, v110, v111
  v_mfma_f32_32x32x16_bf16 v[120:135], v[164:167], v[36:39], v[120:135]
  v_exp_f32 v112, v112
  v_exp_f32 v113, v113
  v_exp_f32 v114, v114
  v_exp_f32 v115, v115
  v_cvt_pk_bf16_f32 v140, v112, v113
  v_cvt_pk_bf16_f32 v141, v114, v115
  v_mfma_f32_32x32x16_bf16 v[72:87], v[168:171], v[136:139], v[72:87]
  s_waitcnt vmcnt(8)
  v_exp_f32 v116, v116
  v_exp_f32 v117, v117
  v_exp_f32 v118, v118
  v_exp_f32 v119, v119
  v_cvt_pk_bf16_f32 v142, v116, v117
  v_cvt_pk_bf16_f32 v143, v118, v119
  v_mfma_f32_32x32x16_bf16 v[104:119], v[176:179], v[8:11], 0
  buffer_load_dwordx4 v[160:163], v249, s[12:15], s30 offen offset:0 sc1
  v_exp_f32 v120, v120
  v_exp_f32 v121, v121
  v_exp_f32 v122, v122
  v_exp_f32 v123, v123
  v_cvt_pk_bf16_f32 v136, v120, v121
  v_cvt_pk_bf16_f32 v137, v122, v123
  v_mfma_f32_32x32x16_bf16 v[72:87], v[172:175], v[140:143], v[72:87]
  buffer_load_dwordx4 v[164:167], v249, s[12:15], s30 offen offset:1024 sc1
  v_exp_f32 v124, v124
  v_exp_f32 v125, v125
  v_exp_f32 v126, v126
  v_exp_f32 v127, v127
  v_cvt_pk_bf16_f32 v138, v124, v125
  v_cvt_pk_bf16_f32 v139, v126, v127
  v_mfma_f32_32x32x16_bf16 v[104:119], v[180:183], v[12:15], v[104:119]
  v_exp_f32 v128, v128
  v_exp_f32 v129, v129
  v_exp_f32 v130, v130
  v_exp_f32 v131, v131
  v_cvt_pk_bf16_f32 v140, v128, v129
  v_cvt_pk_bf16_f32 v141, v130, v131
  v_mfma_f32_32x32x16_bf16 v[88:103], v[168:171], v[136:139], v[88:103]
  v_exp_f32 v132, v132
  v_exp_f32 v133, v133
  v_exp_f32 v134, v134
  v_exp_f32 v135, v135
  v_cvt_pk_bf16_f32 v142, v132, v133
  v_cvt_pk_bf16_f32 v143, v134, v135
  v_mfma_f32_32x32x16_bf16 v[120:135], v[176:179], v[16:19], 0
  v_exp_f32 v104, v104
  v_exp_f32 v105, v105
  v_exp_f32 v106, v106
  v_exp_f32 v107, v107
  v_cvt_pk_bf16_f32 v136, v104, v105
  v_cvt_pk_bf16_f32 v137, v106, v107
  v_mfma_f32_32x32x16_bf16 v[88:103], v[172:175], v[140:143], v[88:103]
  v_exp_f32 v108, v108
  v_exp_f32 v109, v109
  v_exp_f32 v110, v110
  v_exp_f32 v111, v111
  v_cvt_pk_bf16_f32 v138, v108, v109
  v_cvt_pk_bf16_f32 v139, v110, v111
  v_mfma_f32_32x32x16_bf16 v[120:135], v[180:183], v[20:23], v[120:135]
  v_exp_f32 v112, v112
  v_exp_f32 v113, v113
  v_exp_f32 v114, v114
  v_exp_f32 v115, v115
  v_cvt_pk_bf16_f32 v140, v112, v113
  v_cvt_pk_bf16_f32 v141, v114, v115
  v_mfma_f32_32x32x16_bf16 v[40:55], v[184:187], v[136:139], v[40:55]
  v_exp_f32 v116, v116
  v_exp_f32 v117, v117
  v_exp_f32 v118, v118
  v_exp_f32 v119, v119
  v_cvt_pk_bf16_f32 v142, v116, v117
  v_cvt_pk_bf16_f32 v143, v118, v119
  v_mfma_f32_32x32x16_bf16 v[104:119], v[176:179], v[24:27], 0
  buffer_load_dwordx4 v[168:171], v249, s[12:15], s30 offen offset:2048 sc1
  v_exp_f32 v120, v120
  v_exp_f32 v121, v121
  v_exp_f32 v122, v122
  v_exp_f32 v123, v123
  v_cvt_pk_bf16_f32 v136, v120, v121
  v_cvt_pk_bf16_f32 v137, v122, v123
  v_mfma_f32_32x32x16_bf16 v[40:55], v[188:191], v[140:143], v[40:55]
  buffer_load_dwordx4 v[172:175], v249, s[12:15], s30 offen offset:3072 sc1
  v_exp_f32 v124, v124
  v_exp_f32 v125, v125
  v_exp_f32 v126, v126
  v_exp_f32 v127, v127
  v_cvt_pk_bf16_f32 v138, v124, v125
  v_cvt_pk_bf16_f32 v139, v126, v127
  v_mfma_f32_32x32x16_bf16 v[104:119], v[180:183], v[28:31], v[104:119]
  v_exp_f32 v128, v128
  v_exp_f32 v129, v129
  v_exp_f32 v130, v130
  v_exp_f32 v131, v131
  v_cvt_pk_bf16_f32 v140, v128, v129
  v_cvt_pk_bf16_f32 v141, v130, v131
  v_mfma_f32_32x32x16_bf16 v[56:71], v[184:187], v[136:139], v[56:71]
  v_exp_f32 v132, v132
  v_exp_f32 v133, v133
  v_exp_f32 v134, v134
  v_exp_f32 v135, v135
  v_cvt_pk_bf16_f32 v142, v132, v133
  v_cvt_pk_bf16_f32 v143, v134, v135
  v_mfma_f32_32x32x16_bf16 v[120:135], v[176:179], v[32:35], 0
  v_exp_f32 v104, v104
  v_exp_f32 v105, v105
  v_exp_f32 v106, v106
  v_exp_f32 v107, v107
  v_cvt_pk_bf16_f32 v136, v104, v105
  v_cvt_pk_bf16_f32 v137, v106, v107
  v_mfma_f32_32x32x16_bf16 v[56:71], v[188:191], v[140:143], v[56:71]
  v_exp_f32 v108, v108
  v_exp_f32 v109, v109
  v_exp_f32 v110, v110
  v_exp_f32 v111, v111
  v_cvt_pk_bf16_f32 v138, v108, v109
  v_cvt_pk_bf16_f32 v139, v110, v111
  v_mfma_f32_32x32x16_bf16 v[120:135], v[180:183], v[36:39], v[120:135]
  v_exp_f32 v112, v112
  v_exp_f32 v113, v113
  v_exp_f32 v114, v114
  v_exp_f32 v115, v115
  v_cvt_pk_bf16_f32 v140, v112, v113
  v_cvt_pk_bf16_f32 v141, v114, v115
  v_mfma_f32_32x32x16_bf16 v[72:87], v[184:187], v[136:139], v[72:87]
  s_waitcnt vmcnt(8)
  v_exp_f32 v116, v116
  v_exp_f32 v117, v117
  v_exp_f32 v118, v118
  v_exp_f32 v119, v119
  v_cvt_pk_bf16_f32 v142, v116, v117
  v_cvt_pk_bf16_f32 v143, v118, v119
  v_mfma_f32_32x32x16_bf16 v[104:119], v[192:195], v[8:11], 0
  buffer_load_dwordx4 v[176:179], v250, s[12:15], s30 offen offset:0 sc1
  v_exp_f32 v120, v120
  v_exp_f32 v121, v121
  v_exp_f32 v122, v122
  v_exp_f32 v123, v123
  v_cvt_pk_bf16_f32 v136, v120, v121
  v_cvt_pk_bf16_f32 v137, v122, v123
  v_mfma_f32_32x32x16_bf16 v[72:87], v[188:191], v[140:143], v[72:87]
  buffer_load_dwordx4 v[180:183], v250, s[12:15], s30 offen offset:1024 sc1
  v_exp_f32 v124, v124
  v_exp_f32 v125, v125
  v_exp_f32 v126, v126
  v_exp_f32 v127, v127
  v_cvt_pk_bf16_f32 v138, v124, v125
  v_cvt_pk_bf16_f32 v139, v126, v127
  v_mfma_f32_32x32x16_bf16 v[104:119], v[196:199], v[12:15], v[104:119]
  v_exp_f32 v128, v128
  v_exp_f32 v129, v129
  v_exp_f32 v130, v130
  v_exp_f32 v131, v131
  v_cvt_pk_bf16_f32 v140, v128, v129
  v_cvt_pk_bf16_f32 v141, v130, v131
  v_mfma_f32_32x32x16_bf16 v[88:103], v[184:187], v[136:139], v[88:103]
  v_exp_f32 v132, v132
  v_exp_f32 v133, v133
  v_exp_f32 v134, v134
  v_exp_f32 v135, v135
  v_cvt_pk_bf16_f32 v142, v132, v133
  v_cvt_pk_bf16_f32 v143, v134, v135
  v_mfma_f32_32x32x16_bf16 v[120:135], v[192:195], v[16:19], 0
  v_exp_f32 v104, v104
  v_exp_f32 v105, v105
  v_exp_f32 v106, v106
  v_exp_f32 v107, v107
  v_cvt_pk_bf16_f32 v136, v104, v105
  v_cvt_pk_bf16_f32 v137, v106, v107
  v_mfma_f32_32x32x16_bf16 v[88:103], v[188:191], v[140:143], v[88:103]
  v_exp_f32 v108, v108
  v_exp_f32 v109, v109
  v_exp_f32 v110, v110
  v_exp_f32 v111, v111
  v_cvt_pk_bf16_f32 v138, v108, v109
  v_cvt_pk_bf16_f32 v139, v110, v111
  v_mfma_f32_32x32x16_bf16 v[120:135], v[196:199], v[20:23], v[120:135]
  v_exp_f32 v112, v112
  v_exp_f32 v113, v113
  v_exp_f32 v114, v114
  v_exp_f32 v115, v115
  v_cvt_pk_bf16_f32 v140, v112, v113
  v_cvt_pk_bf16_f32 v141, v114, v115
  v_mfma_f32_32x32x16_bf16 v[40:55], v[200:203], v[136:139], v[40:55]
  v_exp_f32 v116, v116
  v_exp_f32 v117, v117
  v_exp_f32 v118, v118
  v_exp_f32 v119, v119
  v_cvt_pk_bf16_f32 v142, v116, v117
  v_cvt_pk_bf16_f32 v143, v118, v119
  v_mfma_f32_32x32x16_bf16 v[104:119], v[192:195], v[24:27], 0
  buffer_load_dwordx4 v[184:187], v250, s[12:15], s30 offen offset:2048 sc1
  v_exp_f32 v120, v120
  v_exp_f32 v121, v121
  v_exp_f32 v122, v122
  v_exp_f32 v123, v123
  v_cvt_pk_bf16_f32 v136, v120, v121
  v_cvt_pk_bf16_f32 v137, v122, v123
  v_mfma_f32_32x32x16_bf16 v[40:55], v[204:207], v[140:143], v[40:55]
  buffer_load_dwordx4 v[188:191], v250, s[12:15], s30 offen offset:3072 sc1
  v_exp_f32 v124, v124
  v_exp_f32 v125, v125
  v_exp_f32 v126, v126
  v_exp_f32 v127, v127
  v_cvt_pk_bf16_f32 v138, v124, v125
  v_cvt_pk_bf16_f32 v139, v126, v127
  v_mfma_f32_32x32x16_bf16 v[104:119], v[196:199], v[28:31], v[104:119]
  v_exp_f32 v128, v128
  v_exp_f32 v129, v129
  v_exp_f32 v130, v130
  v_exp_f32 v131, v131
  v_cvt_pk_bf16_f32 v140, v128, v129
  v_cvt_pk_bf16_f32 v141, v130, v131
  v_mfma_f32_32x32x16_bf16 v[56:71], v[200:203], v[136:139], v[56:71]
  v_exp_f32 v132, v132
  v_exp_f32 v133, v133
  v_exp_f32 v134, v134
  v_exp_f32 v135, v135
  v_cvt_pk_bf16_f32 v142, v132, v133
  v_cvt_pk_bf16_f32 v143, v134, v135
  v_mfma_f32_32x32x16_bf16 v[120:135], v[192:195], v[32:35], 0
  v_exp_f32 v104, v104
  v_exp_f32 v105, v105
  v_exp_f32 v106, v106
  v_exp_f32 v107, v107
  v_cvt_pk_bf16_f32 v136, v104, v105
  v_cvt_pk_bf16_f32 v137, v106, v107
  v_mfma_f32_32x32x16_bf16 v[56:71], v[204:207], v[140:143], v[56:71]
  v_exp_f32 v108, v108
  v_exp_f32 v109, v109
  v_exp_f32 v110, v110
  v_exp_f32 v111, v111
  v_cvt_pk_bf16_f32 v138, v108, v109
  v_cvt_pk_bf16_f32 v139, v110, v111
  v_mfma_f32_32x32x16_bf16 v[120:135], v[196:199], v[36:39], v[120:135]
  v_exp_f32 v112, v112
  v_exp_f32 v113, v113
  v_exp_f32 v114, v114
  v_exp_f32 v115, v115
  v_cvt_pk_bf16_f32 v140, v112, v113
  v_cvt_pk_bf16_f32 v141, v114, v115
  v_mfma_f32_32x32x16_bf16 v[72:87], v[200:203], v[136:139], v[72:87]
  s_waitcnt vmcnt(8)
  v_exp_f32 v116, v116
  v_exp_f32 v117, v117
  v_exp_f32 v118, v118
  v_exp_f32 v119, v119
  v_cvt_pk_bf16_f32 v142, v116, v117
  v_cvt_pk_bf16_f32 v143, v118, v119
  v_mfma_f32_32x32x16_bf16 v[104:119], v[144:147], v[8:11], 0
  buffer_load_dwordx4 v[192:195], v251, s[12:15], s30 offen offset:0 sc1
  v_exp_f32 v120, v120
  v_exp_f32 v121, v121
  v_exp_f32 v122, v122
  v_exp_f32 v123, v123
  v_cvt_pk_bf16_f32 v136, v120, v121
  v_cvt_pk_bf16_f32 v137, v122, v123
  v_mfma_f32_32x32x16_bf16 v[72:87], v[204:207], v[140:143], v[72:87]
  buffer_load_dwordx4 v[196:199], v251, s[12:15], s30 offen offset:1024 sc1
  v_exp_f32 v124, v124
  v_exp_f32 v125, v125
  v_exp_f32 v126, v126
  v_exp_f32 v127, v127
  v_cvt_pk_bf16_f32 v138, v124, v125
  v_cvt_pk_bf16_f32 v139, v126, v127
  v_mfma_f32_32x32x16_bf16 v[104:119], v[148:151], v[12:15], v[104:119]
  v_exp_f32 v128, v128
  v_exp_f32 v129, v129
  v_exp_f32 v130, v130
  v_exp_f32 v131, v131
  v_cvt_pk_bf16_f32 v140, v128, v129
  v_cvt_pk_bf16_f32 v141, v130, v131
  v_mfma_f32_32x32x16_bf16 v[88:103], v[200:203], v[136:139], v[88:103]
  v_exp_f32 v132, v132
  s_add_u32 s31, s31, 16384
  v_exp_f32 v133, v133
  s_add_u32 s30, s30, 16384
  v_exp_f32 v134, v134
  s_cmp_lt_u32 s31, 49152
  v_exp_f32 v135, v135
  v_cvt_pk_bf16_f32 v142, v132, v133
  v_cvt_pk_bf16_f32 v143, v134, v135
  v_mfma_f32_32x32x16_bf16 v[120:135], v[144:147], v[16:19], 0
  v_exp_f32 v104, v104
  v_exp_f32 v105, v105
  v_exp_f32 v106, v106
  v_exp_f32 v107, v107
  v_cvt_pk_bf16_f32 v136, v104, v105
  v_cvt_pk_bf16_f32 v137, v106, v107
  v_mfma_f32_32x32x16_bf16 v[88:103], v[204:207], v[140:143], v[88:103]
  v_exp_f32 v108, v108
  v_exp_f32 v109, v109
  v_exp_f32 v110, v110
  v_exp_f32 v111, v111
  v_cvt_pk_bf16_f32 v138, v108, v109
  v_cvt_pk_bf16_f32 v139, v110, v111
  v_mfma_f32_32x32x16_bf16 v[120:135], v[148:151], v[20:23], v[120:135]
  v_exp_f32 v112, v112
  v_exp_f32 v113, v113
  v_exp_f32 v114, v114
  v_exp_f32 v115, v115
  v_cvt_pk_bf16_f32 v140, v112, v113
  v_cvt_pk_bf16_f32 v141, v114, v115
  v_mfma_f32_32x32x16_bf16 v[40:55], v[152:155], v[136:139], v[40:55]
  v_exp_f32 v116, v116
  v_exp_f32 v117, v117
  v_exp_f32 v118, v118
  v_exp_f32 v119, v119
  v_cvt_pk_bf16_f32 v142, v116, v117
  v_cvt_pk_bf16_f32 v143, v118, v119
  v_mfma_f32_32x32x16_bf16 v[104:119], v[144:147], v[24:27], 0
  buffer_load_dwordx4 v[200:203], v251, s[12:15], s31 offen offset:2048 sc1
  v_exp_f32 v120, v120
  v_exp_f32 v121, v121
  v_exp_f32 v122, v122
  v_exp_f32 v123, v123
  v_cvt_pk_bf16_f32 v136, v120, v121
  v_cvt_pk_bf16_f32 v137, v122, v123
  v_mfma_f32_32x32x16_bf16 v[40:55], v[156:159], v[140:143], v[40:55]
  buffer_load_dwordx4 v[204:207], v251, s[12:15], s31 offen offset:3072 sc1
  v_exp_f32 v124, v124
  v_exp_f32 v125, v125
  v_exp_f32 v126, v126
  v_exp_f32 v127, v127
  v_cvt_pk_bf16_f32 v138, v124, v125
  v_cvt_pk_bf16_f32 v139, v126, v127
  v_mfma_f32_32x32x16_bf16 v[104:119], v[148:151], v[28:31], v[104:119]
  v_exp_f32 v128, v128
  v_exp_f32 v129, v129
  v_exp_f32 v130, v130
  v_exp_f32 v131, v131
  v_cvt_pk_bf16_f32 v140, v128, v129
  v_cvt_pk_bf16_f32 v141, v130, v131
  v_mfma_f32_32x32x16_bf16 v[56:71], v[152:155], v[136:139], v[56:71]
  v_exp_f32 v132, v132
  v_exp_f32 v133, v133
  v_exp_f32 v134, v134
  v_exp_f32 v135, v135
  v_cvt_pk_bf16_f32 v142, v132, v133
  v_cvt_pk_bf16_f32 v143, v134, v135
  v_mfma_f32_32x32x16_bf16 v[120:135], v[144:147], v[32:35], 0
  v_exp_f32 v104, v104
  v_exp_f32 v105, v105
  v_exp_f32 v106, v106
  v_exp_f32 v107, v107
  v_cvt_pk_bf16_f32 v136, v104, v105
  v_cvt_pk_bf16_f32 v137, v106, v107
  v_mfma_f32_32x32x16_bf16 v[56:71], v[156:159], v[140:143], v[56:71]
  v_exp_f32 v108, v108
  v_exp_f32 v109, v109
  v_exp_f32 v110, v110
  v_exp_f32 v111, v111
  v_cvt_pk_bf16_f32 v138, v108, v109
  v_cvt_pk_bf16_f32 v139, v110, v111
  v_mfma_f32_32x32x16_bf16 v[120:135], v[148:151], v[36:39], v[120:135]
  v_exp_f32 v112, v112
  v_exp_f32 v113, v113
  v_exp_f32 v114, v114
  v_exp_f32 v115, v115
  v_cvt_pk_bf16_f32 v140, v112, v113
  v_cvt_pk_bf16_f32 v141, v114, v115
  v_mfma_f32_32x32x16_bf16 v[72:87], v[152:155], v[136:139], v[72:87]
  s_waitcnt vmcnt(8)
  v_exp_f32 v116, v116
  v_exp_f32 v117, v117
  v_exp_f32 v118, v118
  v_exp_f32 v119, v119
  v_cvt_pk_bf16_f32 v142, v116, v117
  v_cvt_pk_bf16_f32 v143, v118, v119
  v_mfma_f32_32x32x16_bf16 v[104:119], v[160:163], v[8:11], 0
  buffer_load_dwordx4 v[144:147], v248, s[12:15], s30 offen offset:0 sc1
  v_exp_f32 v120, v120
  v_exp_f32 v121, v121
  v_exp_f32 v122, v122
  v_exp_f32 v123, v123
  v_cvt_pk_bf16_f32 v136, v120, v121
  v_cvt_pk_bf16_f32 v137, v122, v123
  v_mfma_f32_32x32x16_bf16 v[72:87], v[156:159], v[140:143], v[72:87]
  buffer_load_dwordx4 v[148:151], v248, s[12:15], s30 offen offset:1024 sc1
  v_exp_f32 v124, v124
  v_exp_f32 v125, v125
  v_exp_f32 v126, v126
  v_exp_f32 v127, v127
  v_cvt_pk_bf16_f32 v138, v124, v125
  v_cvt_pk_bf16_f32 v139, v126, v127
  v_mfma_f32_32x32x16_bf16 v[104:119], v[164:167], v[12:15], v[104:119]
  v_exp_f32 v128, v128
  v_exp_f32 v129, v129
  v_exp_f32 v130, v130
  v_exp_f32 v131, v131
  v_cvt_pk_bf16_f32 v140, v128, v129
  v_cvt_pk_bf16_f32 v141, v130, v131
  v_mfma_f32_32x32x16_bf16 v[88:103], v[152:155], v[136:139], v[88:103]
  v_exp_f32 v132, v132
  v_exp_f32 v133, v133
  v_exp_f32 v134, v134
  v_exp_f32 v135, v135
  v_cvt_pk_bf16_f32 v142, v132, v133
  v_cvt_pk_bf16_f32 v143, v134, v135
  v_mfma_f32_32x32x16_bf16 v[120:135], v[160:163], v[16:19], 0
  v_exp_f32 v104, v104
  v_exp_f32 v105, v105
  v_exp_f32 v106, v106
  v_exp_f32 v107, v107
  v_cvt_pk_bf16_f32 v136, v104, v105
  v_cvt_pk_bf16_f32 v137, v106, v107
  v_mfma_f32_32x32x16_bf16 v[88:103], v[156:159], v[140:143], v[88:103]
  v_exp_f32 v108, v108
  v_exp_f32 v109, v109
  v_exp_f32 v110, v110
  v_exp_f32 v111, v111
  v_cvt_pk_bf16_f32 v138, v108, v109
  v_cvt_pk_bf16_f32 v139, v110, v111
  v_mfma_f32_32x32x16_bf16 v[120:135], v[164:167], v[20:23], v[120:135]
  v_exp_f32 v112, v112
  v_exp_f32 v113, v113
  v_exp_f32 v114, v114
  v_exp_f32 v115, v115
  v_cvt_pk_bf16_f32 v140, v112, v113
  v_cvt_pk_bf16_f32 v141, v114, v115
  v_mfma_f32_32x32x16_bf16 v[40:55], v[168:171], v[136:139], v[40:55]
  v_exp_f32 v116, v116
  v_exp_f32 v117, v117
  v_exp_f32 v118, v118
  v_exp_f32 v119, v119
  v_cvt_pk_bf16_f32 v142, v116, v117
  v_cvt_pk_bf16_f32 v143, v118, v119
  v_mfma_f32_32x32x16_bf16 v[104:119], v[160:163], v[24:27], 0
  buffer_load_dwordx4 v[152:155], v248, s[12:15], s30 offen offset:2048 sc1
  v_exp_f32 v120, v120
  v_exp_f32 v121, v121
  v_exp_f32 v122, v122
  v_exp_f32 v123, v123
  v_cvt_pk_bf16_f32 v136, v120, v121
  v_cvt_pk_bf16_f32 v137, v122, v123
  v_mfma_f32_32x32x16_bf16 v[40:55], v[172:175], v[140:143], v[40:55]
  buffer_load_dwordx4 v[156:159], v248, s[12:15], s30 offen offset:3072 sc1
  v_exp_f32 v124, v124
  v_exp_f32 v125, v125
  v_exp_f32 v126, v126
  v_exp_f32 v127, v127
  v_cvt_pk_bf16_f32 v138, v124, v125
  v_cvt_pk_bf16_f32 v139, v126, v127
  v_mfma_f32_32x32x16_bf16 v[104:119], v[164:167], v[28:31], v[104:119]
  v_exp_f32 v128, v128
  v_exp_f32 v129, v129
  v_exp_f32 v130, v130
  v_exp_f32 v131, v131
  v_cvt_pk_bf16_f32 v140, v128, v129
  v_cvt_pk_bf16_f32 v141, v130, v131
  v_mfma_f32_32x32x16_bf16 v[56:71], v[168:171], v[136:139], v[56:71]
  v_exp_f32 v132, v132
  v_exp_f32 v133, v133
  v_exp_f32 v134, v134
  v_exp_f32 v135, v135
  v_cvt_pk_bf16_f32 v142, v132, v133
  v_cvt_pk_bf16_f32 v143, v134, v135
  v_mfma_f32_32x32x16_bf16 v[120:135], v[160:163], v[32:35], 0
  v_exp_f32 v104, v104
  v_exp_f32 v105, v105
  v_exp_f32 v106, v106
  v_exp_f32 v107, v107
  v_cvt_pk_bf16_f32 v136, v104, v105
  v_cvt_pk_bf16_f32 v137, v106, v107
  v_mfma_f32_32x32x16_bf16 v[56:71], v[172:175], v[140:143], v[56:71]
  v_exp_f32 v108, v108
  v_exp_f32 v109, v109
  v_exp_f32 v110, v110
  v_exp_f32 v111, v111
  v_cvt_pk_bf16_f32 v138, v108, v109
  v_cvt_pk_bf16_f32 v139, v110, v111
  v_mfma_f32_32x32x16_bf16 v[120:135], v[164:167], v[36:39], v[120:135]
  v_exp_f32 v112, v112
  v_exp_f32 v113, v113
  v_exp_f32 v114, v114
  v_exp_f32 v115, v115
  v_cvt_pk_bf16_f32 v140, v112, v113
  v_cvt_pk_bf16_f32 v141, v114, v115
  v_mfma_f32_32x32x16_bf16 v[72:87], v[168:171], v[136:139], v[72:87]
  s_waitcnt vmcnt(8)
  v_exp_f32 v116, v116
  v_exp_f32 v117, v117
  v_exp_f32 v118, v118
  v_exp_f32 v119, v119
  v_cvt_pk_bf16_f32 v142, v116, v117
  v_cvt_pk_bf16_f32 v143, v118, v119
  v_mfma_f32_32x32x16_bf16 v[104:119], v[176:179], v[8:11], 0
  buffer_load_dwordx4 v[160:163], v249, s[12:15], s30 offen offset:0 sc1
  v_exp_f32 v120, v120
  v_exp_f32 v121, v121
  v_exp_f32 v122, v122
  v_exp_f32 v123, v123
  v_cvt_pk_bf16_f32 v136, v120, v121
  v_cvt_pk_bf16_f32 v137, v122, v123
  v_mfma_f32_32x32x16_bf16 v[72:87], v[172:175], v[140:143], v[72:87]
  buffer_load_dwordx4 v[164:167], v249, s[12:15], s30 offen offset:1024 sc1
  v_exp_f32 v124, v124
  v_exp_f32 v125, v125
  v_exp_f32 v126, v126
  v_exp_f32 v127, v127
  v_cvt_pk_bf16_f32 v138, v124, v125
  v_cvt_pk_bf16_f32 v139, v126, v127
  v_mfma_f32_32x32x16_bf16 v[104:119], v[180:183], v[12:15], v[104:119]
  v_exp_f32 v128, v128
  v_exp_f32 v129, v129
  v_exp_f32 v130, v130
  v_exp_f32 v131, v131
  v_cvt_pk_bf16_f32 v140, v128, v129
  v_cvt_pk_bf16_f32 v141, v130, v131
  v_mfma_f32_32x32x16_bf16 v[88:103], v[168:171], v[136:139], v[88:103]
  v_exp_f32 v132, v132
  v_exp_f32 v133, v133
  v_exp_f32 v134, v134
  v_exp_f32 v135, v135
  v_cvt_pk_bf16_f32 v142, v132, v133
  v_cvt_pk_bf16_f32 v143, v134, v135
  v_mfma_f32_32x32x16_bf16 v[120:135], v[176:179], v[16:19], 0
  v_exp_f32 v104, v104
  v_exp_f32 v105, v105
  v_exp_f32 v106, v106
  v_exp_f32 v107, v107
  v_cvt_pk_bf16_f32 v136, v104, v105
  v_cvt_pk_bf16_f32 v137, v106, v107
  v_mfma_f32_32x32x16_bf16 v[88:103], v[172:175], v[140:143], v[88:103]
  v_exp_f32 v108, v108
  v_exp_f32 v109, v109
  v_exp_f32 v110, v110
  v_exp_f32 v111, v111
  v_cvt_pk_bf16_f32 v138, v108, v109
  v_cvt_pk_bf16_f32 v139, v110, v111
  v_mfma_f32_32x32x16_bf16 v[120:135], v[180:183], v[20:23], v[120:135]
  v_exp_f32 v112, v112
  v_exp_f32 v113, v113
  v_exp_f32 v114, v114
  v_exp_f32 v115, v115
  v_cvt_pk_bf16_f32 v140, v112, v113
  v_cvt_pk_bf16_f32 v141, v114, v115
  v_mfma_f32_32x32x16_bf16 v[40:55], v[184:187], v[136:139], v[40:55]
  v_exp_f32 v116, v116
  v_exp_f32 v117, v117
  v_exp_f32 v118, v118
  v_exp_f32 v119, v119
  v_cvt_pk_bf16_f32 v142, v116, v117
  v_cvt_pk_bf16_f32 v143, v118, v119
  v_mfma_f32_32x32x16_bf16 v[104:119], v[176:179], v[24:27], 0
  buffer_load_dwordx4 v[168:171], v249, s[12:15], s30 offen offset:2048 sc1
  v_exp_f32 v120, v120
  v_exp_f32 v121, v121
  v_exp_f32 v122, v122
  v_exp_f32 v123, v123
  v_cvt_pk_bf16_f32 v136, v120, v121
  v_cvt_pk_bf16_f32 v137, v122, v123
  v_mfma_f32_32x32x16_bf16 v[40:55], v[188:191], v[140:143], v[40:55]
  buffer_load_dwordx4 v[172:175], v249, s[12:15], s30 offen offset:3072 sc1
  v_exp_f32 v124, v124
  v_exp_f32 v125, v125
  v_exp_f32 v126, v126
  v_exp_f32 v127, v127
  v_cvt_pk_bf16_f32 v138, v124, v125
  v_cvt_pk_bf16_f32 v139, v126, v127
  v_mfma_f32_32x32x16_bf16 v[104:119], v[180:183], v[28:31], v[104:119]
  v_exp_f32 v128, v128
  v_exp_f32 v129, v129
  v_exp_f32 v130, v130
  v_exp_f32 v131, v131
  v_cvt_pk_bf16_f32 v140, v128, v129
  v_cvt_pk_bf16_f32 v141, v130, v131
  v_mfma_f32_32x32x16_bf16 v[56:71], v[184:187], v[136:139], v[56:71]
  v_exp_f32 v132, v132
  v_exp_f32 v133, v133
  v_exp_f32 v134, v134
  v_exp_f32 v135, v135
  v_cvt_pk_bf16_f32 v142, v132, v133
  v_cvt_pk_bf16_f32 v143, v134, v135
  v_mfma_f32_32x32x16_bf16 v[120:135], v[176:179], v[32:35], 0
  v_exp_f32 v104, v104
  v_exp_f32 v105, v105
  v_exp_f32 v106, v106
  v_exp_f32 v107, v107
  v_cvt_pk_bf16_f32 v136, v104, v105
  v_cvt_pk_bf16_f32 v137, v106, v107
  v_mfma_f32_32x32x16_bf16 v[56:71], v[188:191], v[140:143], v[56:71]
  v_exp_f32 v108, v108
  v_exp_f32 v109, v109
  v_exp_f32 v110, v110
  v_exp_f32 v111, v111
  v_cvt_pk_bf16_f32 v138, v108, v109
  v_cvt_pk_bf16_f32 v139, v110, v111
  v_mfma_f32_32x32x16_bf16 v[120:135], v[180:183], v[36:39], v[120:135]
  v_exp_f32 v112, v112
  v_exp_f32 v113, v113
  v_exp_f32 v114, v114
  v_exp_f32 v115, v115
  v_cvt_pk_bf16_f32 v140, v112, v113
  v_cvt_pk_bf16_f32 v141, v114, v115
  v_mfma_f32_32x32x16_bf16 v[72:87], v[184:187], v[136:139], v[72:87]
  s_waitcnt vmcnt(8)
  v_exp_f32 v116, v116
  v_exp_f32 v117, v117
  v_exp_f32 v118, v118
  v_exp_f32 v119, v119
  v_cvt_pk_bf16_f32 v142, v116, v117
  v_cvt_pk_bf16_f32 v143, v118, v119
  v_mfma_f32_32x32x16_bf16 v[104:119], v[192:195], v[8:11], 0
  buffer_load_dwordx4 v[176:179], v250, s[12:15], s30 offen offset:0 sc1
  v_exp_f32 v120, v120
  v_exp_f32 v121, v121
  v_exp_f32 v122, v122
  v_exp_f32 v123, v123
  v_cvt_pk_bf16_f32 v136, v120, v121
  v_cvt_pk_bf16_f32 v137, v122, v123
  v_mfma_f32_32x32x16_bf16 v[72:87], v[188:191], v[140:143], v[72:87]
  buffer_load_dwordx4 v[180:183], v250, s[12:15], s30 offen offset:1024 sc1
  v_exp_f32 v124, v124
  v_exp_f32 v125, v125
  v_exp_f32 v126, v126
  v_exp_f32 v127, v127
  v_cvt_pk_bf16_f32 v138, v124, v125
  v_cvt_pk_bf16_f32 v139, v126, v127
  v_mfma_f32_32x32x16_bf16 v[104:119], v[196:199], v[12:15], v[104:119]
  v_exp_f32 v128, v128
  v_exp_f32 v129, v129
  v_exp_f32 v130, v130
  v_exp_f32 v131, v131
  v_cvt_pk_bf16_f32 v140, v128, v129
  v_cvt_pk_bf16_f32 v141, v130, v131
  v_mfma_f32_32x32x16_bf16 v[88:103], v[184:187], v[136:139], v[88:103]
  v_exp_f32 v132, v132
  v_exp_f32 v133, v133
  v_exp_f32 v134, v134
  v_exp_f32 v135, v135
  v_cvt_pk_bf16_f32 v142, v132, v133
  v_cvt_pk_bf16_f32 v143, v134, v135
  v_mfma_f32_32x32x16_bf16 v[120:135], v[192:195], v[16:19], 0
  v_exp_f32 v104, v104
  v_exp_f32 v105, v105
  v_exp_f32 v106, v106
  v_exp_f32 v107, v107
  v_cvt_pk_bf16_f32 v136, v104, v105
  v_cvt_pk_bf16_f32 v137, v106, v107
  v_mfma_f32_32x32x16_bf16 v[88:103], v[188:191], v[140:143], v[88:103]
  v_exp_f32 v108, v108
  v_exp_f32 v109, v109
  v_exp_f32 v110, v110
  v_exp_f32 v111, v111
  v_cvt_pk_bf16_f32 v138, v108, v109
  v_cvt_pk_bf16_f32 v139, v110, v111
  v_mfma_f32_32x32x16_bf16 v[120:135], v[196:199], v[20:23], v[120:135]
  v_exp_f32 v112, v112
  v_exp_f32 v113, v113
  v_exp_f32 v114, v114
  v_exp_f32 v115, v115
  v_cvt_pk_bf16_f32 v140, v112, v113
  v_cvt_pk_bf16_f32 v141, v114, v115
  v_mfma_f32_32x32x16_bf16 v[40:55], v[200:203], v[136:139], v[40:55]
  v_exp_f32 v116, v116
  v_exp_f32 v117, v117
  v_exp_f32 v118, v118
  v_exp_f32 v119, v119
  v_cvt_pk_bf16_f32 v142, v116, v117
  v_cvt_pk_bf16_f32 v143, v118, v119
  v_mfma_f32_32x32x16_bf16 v[104:119], v[192:195], v[24:27], 0
  buffer_load_dwordx4 v[184:187], v250, s[12:15], s30 offen offset:2048 sc1
  v_exp_f32 v120, v120
  v_exp_f32 v121, v121
  v_exp_f32 v122, v122
  v_exp_f32 v123, v123
  v_cvt_pk_bf16_f32 v136, v120, v121
  v_cvt_pk_bf16_f32 v137, v122, v123
  v_mfma_f32_32x32x16_bf16 v[40:55], v[204:207], v[140:143], v[40:55]
  buffer_load_dwordx4 v[188:191], v250, s[12:15], s30 offen offset:3072 sc1
  v_exp_f32 v124, v124
  v_exp_f32 v125, v125
  v_exp_f32 v126, v126
  v_exp_f32 v127, v127
  v_cvt_pk_bf16_f32 v138, v124, v125
  v_cvt_pk_bf16_f32 v139, v126, v127
  v_mfma_f32_32x32x16_bf16 v[104:119], v[196:199], v[28:31], v[104:119]
  v_exp_f32 v128, v128
  v_exp_f32 v129, v129
  v_exp_f32 v130, v130
  v_exp_f32 v131, v131
  v_cvt_pk_bf16_f32 v140, v128, v129
  v_cvt_pk_bf16_f32 v141, v130, v131
  v_mfma_f32_32x32x16_bf16 v[56:71], v[200:203], v[136:139], v[56:71]
  v_exp_f32 v132, v132
  v_exp_f32 v133, v133
  v_exp_f32 v134, v134
  v_exp_f32 v135, v135
  v_cvt_pk_bf16_f32 v142, v132, v133
  v_cvt_pk_bf16_f32 v143, v134, v135
  v_mfma_f32_32x32x16_bf16 v[120:135], v[192:195], v[32:35], 0
  v_exp_f32 v104, v104
  v_exp_f32 v105, v105
  v_exp_f32 v106, v106
  v_exp_f32 v107, v107
  v_cvt_pk_bf16_f32 v136, v104, v105
  v_cvt_pk_bf16_f32 v137, v106, v107
  v_mfma_f32_32x32x16_bf16 v[56:71], v[204:207], v[140:143], v[56:71]
  v_exp_f32 v108, v108
  v_exp_f32 v109, v109
  v_exp_f32 v110, v110
  v_exp_f32 v111, v111
  v_cvt_pk_bf16_f32 v138, v108, v109
  v_cvt_pk_bf16_f32 v139, v110, v111
  v_mfma_f32_32x32x16_bf16 v[120:135], v[196:199], v[36:39], v[120:135]
  v_exp_f32 v112, v112
  v_exp_f32 v113, v113
  v_exp_f32 v114, v114
  v_exp_f32 v115, v115
  v_cvt_pk_bf16_f32 v140, v112, v113
  v_cvt_pk_bf16_f32 v141, v114, v115
  v_mfma_f32_32x32x16_bf16 v[72:87], v[200:203], v[136:139], v[72:87]
  s_waitcnt vmcnt(8)
  v_exp_f32 v116, v116
  v_exp_f32 v117, v117
  v_exp_f32 v118, v118
  v_exp_f32 v119, v119
  v_cvt_pk_bf16_f32 v142, v116, v117
  v_cvt_pk_bf16_f32 v143, v118, v119
  v_mfma_f32_32x32x16_bf16 v[104:119], v[144:147], v[8:11], 0
  buffer_load_dwordx4 v[192:195], v251, s[12:15], s30 offen offset:0 sc1
  v_exp_f32 v120, v120
  v_exp_f32 v121, v121
  v_exp_f32 v122, v122
  v_exp_f32 v123, v123
  v_cvt_pk_bf16_f32 v136, v120, v121
  v_cvt_pk_bf16_f32 v137, v122, v123
  v_mfma_f32_32x32x16_bf16 v[72:87], v[204:207], v[140:143], v[72:87]
  buffer_load_dwordx4 v[196:199], v251, s[12:15], s30 offen offset:1024 sc1
  v_exp_f32 v124, v124
  v_exp_f32 v125, v125
  v_exp_f32 v126, v126
  v_exp_f32 v127, v127
  v_cvt_pk_bf16_f32 v138, v124, v125
  v_cvt_pk_bf16_f32 v139, v126, v127
  v_mfma_f32_32x32x16_bf16 v[104:119], v[148:151], v[12:15], v[104:119]
  v_exp_f32 v128, v128
  v_exp_f32 v129, v129
  v_exp_f32 v130, v130
  v_exp_f32 v131, v131
  v_cvt_pk_bf16_f32 v140, v128, v129
  v_cvt_pk_bf16_f32 v141, v130, v131
  v_mfma_f32_32x32x16_bf16 v[88:103], v[200:203], v[136:139], v[88:103]
  v_exp_f32 v132, v132
  s_add_u32 s31, s31, 16384
  v_exp_f32 v133, v133
  s_add_u32 s30, s30, 16384
  v_exp_f32 v134, v134
  s_cmp_lt_u32 s31, 49152
  v_exp_f32 v135, v135
  v_cvt_pk_bf16_f32 v142, v132, v133
  v_cvt_pk_bf16_f32 v143, v134, v135
L_LAST:
  v_mfma_f32_32x32x16_bf16 v[120:135], v[144:147], v[16:19], 0
  v_exp_f32 v104, v104
  v_exp_f32 v105, v105
  v_exp_f32 v106, v106
  v_exp_f32 v107, v107
  v_cvt_pk_bf16_f32 v136, v104, v105
  v_cvt_pk_bf16_f32 v137, v106, v107
  v_mfma_f32_32x32x16_bf16 v[88:103], v[204:207], v[140:143], v[88:103]
  v_exp_f32 v108, v108
  v_exp_f32 v109, v109
  v_exp_f32 v110, v110
  v_exp_f32 v111, v111
  v_cvt_pk_bf16_f32 v138, v108, v109
  v_cvt_pk_bf16_f32 v139, v110, v111
  v_mfma_f32_32x32x16_bf16 v[120:135], v[148:151], v[20:23], v[120:135]
  v_exp_f32 v112, v112
  v_exp_f32 v113, v113
  v_exp_f32 v114, v114
  v_exp_f32 v115, v115
  v_cvt_pk_bf16_f32 v140, v112, v113
  v_cvt_pk_bf16_f32 v141, v114, v115
  v_mfma_f32_32x32x16_bf16 v[40:55], v[152:155], v[136:139], v[40:55]
  v_exp_f32 v116, v116
  v_exp_f32 v117, v117
  v_exp_f32 v118, v118
  v_exp_f32 v119, v119
  v_cvt_pk_bf16_f32 v142, v116, v117
  v_cvt_pk_bf16_f32 v143, v118, v119
  v_mfma_f32_32x32x16_bf16 v[104:119], v[144:147], v[24:27], 0
  buffer_load_dwordx4 v[200:203], v251, s[12:15], s31 offen offset:2048 sc1
  v_exp_f32 v120, v120
  v_exp_f32 v121, v121
  v_exp_f32 v122, v122
  v_exp_f32 v123, v123
  v_cvt_pk_bf16_f32 v136, v120, v121
  v_cvt_pk_bf16_f32 v137, v122, v123
  v_mfma_f32_32x32x16_bf16 v[40:55], v[156:159], v[140:143], v[40:55]
  buffer_load_dwordx4 v[204:207], v251, s[12:15], s31 offen offset:3072 sc1
  v_exp_f32 v124, v124
  v_exp_f32 v125, v125
  v_exp_f32 v126, v126
  v_exp_f32 v127, v127
  v_cvt_pk_bf16_f32 v138, v124, v125
  v_cvt_pk_bf16_f32 v139, v126, v127
  v_mfma_f32_32x32x16_bf16 v[104:119], v[148:151], v[28:31], v[104:119]
  v_exp_f32 v128, v128
  v_exp_f32 v129, v129
  v_exp_f32 v130, v130
  v_exp_f32 v131, v131
  v_cvt_pk_bf16_f32 v140, v128, v129
  v_cvt_pk_bf16_f32 v141, v130, v131
  v_mfma_f32_32x32x16_bf16 v[56:71], v[152:155], v[136:139], v[56:71]
  v_exp_f32 v132, v132
  v_exp_f32 v133, v133
  v_exp_f32 v134, v134
  v_exp_f32 v135, v135
  v_cvt_pk_bf16_f32 v142, v132, v133
  v_cvt_pk_bf16_f32 v143, v134, v135
  v_mfma_f32_32x32x16_bf16 v[120:135], v[144:147], v[32:35], 0
  v_exp_f32 v104, v104
  v_exp_f32 v105, v105
  v_exp_f32 v106, v106
  v_exp_f32 v107, v107
  v_cvt_pk_bf16_f32 v136, v104, v105
  v_cvt_pk_bf16_f32 v137, v106, v107
  v_mfma_f32_32x32x16_bf16 v[56:71], v[156:159], v[140:143], v[56:71]
  v_exp_f32 v108, v108
  v_exp_f32 v109, v109
  v_exp_f32 v110, v110
  v_exp_f32 v111, v111
  v_cvt_pk_bf16_f32 v138, v108, v109
  v_cvt_pk_bf16_f32 v139, v110, v111
  v_mfma_f32_32x32x16_bf16 v[120:135], v[148:151], v[36:39], v[120:135]
  v_exp_f32 v112, v112
  v_exp_f32 v113, v113
  v_exp_f32 v114, v114
  v_exp_f32 v115, v115
  v_cvt_pk_bf16_f32 v140, v112, v113
  v_cvt_pk_bf16_f32 v141, v114, v115
  v_mfma_f32_32x32x16_bf16 v[72:87], v[152:155], v[136:139], v[72:87]
  s_waitcnt vmcnt(8)
  v_exp_f32 v116, v116
  v_exp_f32 v117, v117
  v_exp_f32 v118, v118
  v_exp_f32 v119, v119
  v_cvt_pk_bf16_f32 v142, v116, v117
  v_cvt_pk_bf16_f32 v143, v118, v119
  v_mfma_f32_32x32x16_bf16 v[104:119], v[160:163], v[8:11], 0
  v_exp_f32 v120, v120
  v_exp_f32 v121, v121
  v_exp_f32 v122, v122
  v_exp_f32 v123, v123
  v_cvt_pk_bf16_f32 v136, v120, v121
  v_cvt_pk_bf16_f32 v137, v122, v123
  v_mfma_f32_32x32x16_bf16 v[72:87], v[156:159], v[140:143], v[72:87]
  v_exp_f32 v124, v124
  v_exp_f32 v125, v125
  v_exp_f32 v126, v126
  v_exp_f32 v127, v127
  v_cvt_pk_bf16_f32 v138, v124, v125
  v_cvt_pk_bf16_f32 v139, v126, v127
  v_mfma_f32_32x32x16_bf16 v[104:119], v[164:167], v[12:15], v[104:119]
  v_exp_f32 v128, v128
  v_exp_f32 v129, v129
  v_exp_f32 v130, v130
  v_exp_f32 v131, v131
  v_cvt_pk_bf16_f32 v140, v128, v129
  v_cvt_pk_bf16_f32 v141, v130, v131
  v_mfma_f32_32x32x16_bf16 v[88:103], v[152:155], v[136:139], v[88:103]
  v_exp_f32 v132, v132
  v_exp_f32 v133, v133
  v_exp_f32 v134, v134
  v_exp_f32 v135, v135
  v_cvt_pk_bf16_f32 v142, v132, v133
  v_cvt_pk_bf16_f32 v143, v134, v135
  v_mfma_f32_32x32x16_bf16 v[120:135], v[160:163], v[16:19], 0
  v_exp_f32 v104, v104
  v_exp_f32 v105, v105
  v_exp_f32 v106, v106
  v_exp_f32 v107, v107
  v_cvt_pk_bf16_f32 v136, v104, v105
  v_cvt_pk_bf16_f32 v137, v106, v107
  v_mfma_f32_32x32x16_bf16 v[88:103], v[156:159], v[140:143], v[88:103]
  v_exp_f32 v108, v108
  v_exp_f32 v109, v109
  v_exp_f32 v110, v110
  v_exp_f32 v111, v111
  v_cvt_pk_bf16_f32 v138, v108, v109
  v_cvt_pk_bf16_f32 v139, v110, v111
  v_mfma_f32_32x32x16_bf16 v[120:135], v[164:167], v[20:23], v[120:135]
  v_exp_f32 v112, v112
  v_exp_f32 v113, v113
  v_exp_f32 v114, v114
  v_exp_f32 v115, v115
  v_cvt_pk_bf16_f32 v140, v112, v113
  v_cvt_pk_bf16_f32 v141, v114, v115
  v_mfma_f32_32x32x16_bf16 v[40:55], v[168:171], v[136:139], v[40:55]
  v_exp_f32 v116, v116
  v_exp_f32 v117, v117
  v_exp_f32 v118, v118
  v_exp_f32 v119, v119
  v_cvt_pk_bf16_f32 v142, v116, v117
  v_cvt_pk_bf16_f32 v143, v118, v119
  v_mfma_f32_32x32x16_bf16 v[104:119], v[160:163], v[24:27], 0
  v_exp_f32 v120, v120
  v_exp_f32 v121, v121
  v_exp_f32 v122, v122
  v_exp_f32 v123, v123
  v_cvt_pk_bf16_f32 v136, v120, v121
  v_cvt_pk_bf16_f32 v137, v122, v123
  v_mfma_f32_32x32x16_bf16 v[40:55], v[172:175], v[140:143], v[40:55]
  v_exp_f32 v124, v124
  v_exp_f32 v125, v125
  v_exp_f32 v126, v126
  v_exp_f32 v127, v127
  v_cvt_pk_bf16_f32 v138, v124, v125
  v_cvt_pk_bf16_f32 v139, v126, v127
  v_mfma_f32_32x32x16_bf16 v[104:119], v[164:167], v[28:31], v[104:119]
  v_exp_f32 v128, v128
  v_exp_f32 v129, v129
  v_exp_f32 v130, v130
  v_exp_f32 v131, v131
  v_cvt_pk_bf16_f32 v140, v128, v129
  v_cvt_pk_bf16_f32 v141, v130, v131
  v_mfma_f32_32x32x16_bf16 v[56:71], v[168:171], v[136:139], v[56:71]
  v_exp_f32 v132, v132
  v_exp_f32 v133, v133
  v_exp_f32 v134, v134
  v_exp_f32 v135, v135
  v_cvt_pk_bf16_f32 v142, v132, v133
  v_cvt_pk_bf16_f32 v143, v134, v135
  v_mfma_f32_32x32x16_bf16 v[120:135], v[160:163], v[32:35], 0
  v_exp_f32 v104, v104
  v_exp_f32 v105, v105
  v_exp_f32 v106, v106
  v_exp_f32 v107, v107
  v_cvt_pk_bf16_f32 v136, v104, v105
  v_cvt_pk_bf16_f32 v137, v106, v107
  v_mfma_f32_32x32x16_bf16 v[56:71], v[172:175], v[140:143], v[56:71]
  v_exp_f32 v108, v108
  v_exp_f32 v109, v109
  v_exp_f32 v110, v110
  v_exp_f32 v111, v111
  v_cvt_pk_bf16_f32 v138, v108, v109
  v_cvt_pk_bf16_f32 v139, v110, v111
  v_mfma_f32_32x32x16_bf16 v[120:135], v[164:167], v[36:39], v[120:135]
  v_exp_f32 v112, v112
  v_exp_f32 v113, v113
  v_exp_f32 v114, v114
  v_exp_f32 v115, v115
  v_cvt_pk_bf16_f32 v140, v112, v113
  v_cvt_pk_bf16_f32 v141, v114, v115
  v_mfma_f32_32x32x16_bf16 v[72:87], v[168:171], v[136:139], v[72:87]
  s_waitcnt vmcnt(4)
  v_exp_f32 v116, v116
  v_exp_f32 v117, v117
  v_exp_f32 v118, v118
  v_exp_f32 v119, v119
  v_cvt_pk_bf16_f32 v142, v116, v117
  v_cvt_pk_bf16_f32 v143, v118, v119
  v_mfma_f32_32x32x16_bf16 v[104:119], v[176:179], v[8:11], 0
  v_exp_f32 v120, v120
  v_exp_f32 v121, v121
  v_exp_f32 v122, v122
  v_exp_f32 v123, v123
  v_cvt_pk_bf16_f32 v136, v120, v121
  v_cvt_pk_bf16_f32 v137, v122, v123
  v_mfma_f32_32x32x16_bf16 v[72:87], v[172:175], v[140:143], v[72:87]
  v_exp_f32 v124, v124
  v_exp_f32 v125, v125
  v_exp_f32 v126, v126
  v_exp_f32 v127, v127
  v_cvt_pk_bf16_f32 v138, v124, v125
  v_cvt_pk_bf16_f32 v139, v126, v127
  v_mfma_f32_32x32x16_bf16 v[104:119], v[180:183], v[12:15], v[104:119]
  v_exp_f32 v128, v128
  v_exp_f32 v129, v129
  v_exp_f32 v130, v130
  v_exp_f32 v131, v131
  v_cvt_pk_bf16_f32 v140, v128, v129
  v_cvt_pk_bf16_f32 v141, v130, v131
  v_mfma_f32_32x32x16_bf16 v[88:103], v[168:171], v[136:139], v[88:103]
  v_exp_f32 v132, v132
  v_exp_f32 v133, v133
  v_exp_f32 v134, v134
  v_exp_f32 v135, v135
  v_cvt_pk_bf16_f32 v142, v132, v133
  v_cvt_pk_bf16_f32 v143, v134, v135
  v_mfma_f32_32x32x16_bf16 v[120:135], v[176:179], v[16:19], 0
  v_exp_f32 v104, v104
  v_exp_f32 v105, v105
  v_exp_f32 v106, v106
  v_exp_f32 v107, v107
  v_cvt_pk_bf16_f32 v136, v104, v105
  v_cvt_pk_bf16_f32 v137, v106, v107
  v_mfma_f32_32x32x16_bf16 v[88:103], v[172:175], v[140:143], v[88:103]
  v_exp_f32 v108, v108
  v_exp_f32 v109, v109
  v_exp_f32 v110, v110
  v_exp_f32 v111, v111
  v_cvt_pk_bf16_f32 v138, v108, v109
  v_cvt_pk_bf16_f32 v139, v110, v111
  v_mfma_f32_32x32x16_bf16 v[120:135], v[180:183], v[20:23], v[120:135]
  v_exp_f32 v112, v112
  v_exp_f32 v113, v113
  v_exp_f32 v114, v114
  v_exp_f32 v115, v115
  v_cvt_pk_bf16_f32 v140, v112, v113
  v_cvt_pk_bf16_f32 v141, v114, v115
  v_mfma_f32_32x32x16_bf16 v[40:55], v[184:187], v[136:139], v[40:55]
  v_exp_f32 v116, v116
  v_exp_f32 v117, v117
  v_exp_f32 v118, v118
  v_exp_f32 v119, v119
  v_cvt_pk_bf16_f32 v142, v116, v117
  v_cvt_pk_bf16_f32 v143, v118, v119
  v_mfma_f32_32x32x16_bf16 v[104:119], v[176:179], v[24:27], 0
  v_exp_f32 v120, v120
  v_exp_f32 v121, v121
  v_exp_f32 v122, v122
  v_exp_f32 v123, v123
  v_cvt_pk_bf16_f32 v136, v120, v121
  v_cvt_pk_bf16_f32 v137, v122, v123
  v_mfma_f32_32x32x16_bf16 v[40:55], v[188:191], v[140:143], v[40:55]
  v_exp_f32 v124, v124
  v_exp_f32 v125, v125
  v_exp_f32 v126, v126
  v_exp_f32 v127, v127
  v_cvt_pk_bf16_f32 v138, v124, v125
  v_cvt_pk_bf16_f32 v139, v126, v127
  v_mfma_f32_32x32x16_bf16 v[104:119], v[180:183], v[28:31], v[104:119]
  v_exp_f32 v128, v128
  v_exp_f32 v129, v129
  v_exp_f32 v130, v130
  v_exp_f32 v131, v131
  v_cvt_pk_bf16_f32 v140, v128, v129
  v_cvt_pk_bf16_f32 v141, v130, v131
  v_mfma_f32_32x32x16_bf16 v[56:71], v[184:187], v[136:139], v[56:71]
  v_exp_f32 v132, v132
  v_exp_f32 v133, v133
  v_exp_f32 v134, v134
  v_exp_f32 v135, v135
  v_cvt_pk_bf16_f32 v142, v132, v133
  v_cvt_pk_bf16_f32 v143, v134, v135
  v_mfma_f32_32x32x16_bf16 v[120:135], v[176:179], v[32:35], 0
  v_exp_f32 v104, v104
  v_exp_f32 v105, v105
  v_exp_f32 v106, v106
  v_exp_f32 v107, v107
  v_cvt_pk_bf16_f32 v136, v104, v105
  v_cvt_pk_bf16_f32 v137, v106, v107
  v_mfma_f32_32x32x16_bf16 v[56:71], v[188:191], v[140:143], v[56:71]
  v_exp_f32 v108, v108
  v_exp_f32 v109, v109
  v_exp_f32 v110, v110
  v_exp_f32 v111, v111
  v_cvt_pk_bf16_f32 v138, v108, v109
  v_cvt_pk_bf16_f32 v139, v110, v111
  v_mfma_f32_32x32x16_bf16 v[120:135], v[180:183], v[36:39], v[120:135]
  v_exp_f32 v112, v112
  v_exp_f32 v113, v113
  v_exp_f32 v114, v114
  v_exp_f32 v115, v115
  v_cvt_pk_bf16_f32 v140, v112, v113
  v_cvt_pk_bf16_f32 v141, v114, v115
  v_mfma_f32_32x32x16_bf16 v[72:87], v[184:187], v[136:139], v[72:87]
  s_waitcnt vmcnt(0)
  v_exp_f32 v116, v116
  v_exp_f32 v117, v117
  v_exp_f32 v118, v118
  v_exp_f32 v119, v119
  v_cvt_pk_bf16_f32 v142, v116, v117
  v_cvt_pk_bf16_f32 v143, v118, v119
  v_mfma_f32_32x32x16_bf16 v[104:119], v[192:195], v[8:11], 0
  v_exp_f32 v120, v120
  v_exp_f32 v121, v121
  v_exp_f32 v122, v122
  v_exp_f32 v123, v123
  v_cvt_pk_bf16_f32 v136, v120, v121
  v_cvt_pk_bf16_f32 v137, v122, v123
  v_mfma_f32_32x32x16_bf16 v[72:87], v[188:191], v[140:143], v[72:87]
  v_exp_f32 v124, v124
  v_exp_f32 v125, v125
  v_exp_f32 v126, v126
  v_exp_f32 v127, v127
  v_cvt_pk_bf16_f32 v138, v124, v125
  v_cvt_pk_bf16_f32 v139, v126, v127
  v_mfma_f32_32x32x16_bf16 v[104:119], v[196:199], v[12:15], v[104:119]
  v_exp_f32 v128, v128
  v_exp_f32 v129, v129
  v_exp_f32 v130, v130
  v_exp_f32 v131, v131
  v_cvt_pk_bf16_f32 v140, v128, v129
  v_cvt_pk_bf16_f32 v141, v130, v131
  v_mfma_f32_32x32x16_bf16 v[88:103], v[184:187], v[136:139], v[88:103]
  v_exp_f32 v132, v132
  v_exp_f32 v133, v133
  v_exp_f32 v134, v134
  v_exp_f32 v135, v135
  v_cvt_pk_bf16_f32 v142, v132, v133
  v_cvt_pk_bf16_f32 v143, v134, v135
  v_mfma_f32_32x32x16_bf16 v[120:135], v[192:195], v[16:19], 0
  v_exp_f32 v104, v104
  v_exp_f32 v105, v105
  v_exp_f32 v106, v106
  v_exp_f32 v107, v107
  v_cvt_pk_bf16_f32 v136, v104, v105
  v_cvt_pk_bf16_f32 v137, v106, v107
  v_mfma_f32_32x32x16_bf16 v[88:103], v[188:191], v[140:143], v[88:103]
  v_exp_f32 v108, v108
  v_exp_f32 v109, v109
  v_exp_f32 v110, v110
  v_exp_f32 v111, v111
  v_cvt_pk_bf16_f32 v138, v108, v109
  v_cvt_pk_bf16_f32 v139, v110, v111
  v_mfma_f32_32x32x16_bf16 v[120:135], v[196:199], v[20:23], v[120:135]
  v_exp_f32 v112, v112
  v_exp_f32 v113, v113
  v_exp_f32 v114, v114
  v_exp_f32 v115, v115
  v_cvt_pk_bf16_f32 v140, v112, v113
  v_cvt_pk_bf16_f32 v141, v114, v115
  v_mfma_f32_32x32x16_bf16 v[40:55], v[200:203], v[136:139], v[40:55]
  v_exp_f32 v116, v116
  v_exp_f32 v117, v117
  v_exp_f32 v118, v118
  v_exp_f32 v119, v119
  v_cvt_pk_bf16_f32 v142, v116, v117
  v_cvt_pk_bf16_f32 v143, v118, v119
  v_mfma_f32_32x32x16_bf16 v[104:119], v[192:195], v[24:27], 0
  v_exp_f32 v120, v120
  v_exp_f32 v121, v121
  v_exp_f32 v122, v122
  v_exp_f32 v123, v123
  v_cvt_pk_bf16_f32 v136, v120, v121
  v_cvt_pk_bf16_f32 v137, v122, v123
  v_mfma_f32_32x32x16_bf16 v[40:55], v[204:207], v[140:143], v[40:55]
  v_exp_f32 v124, v124
  v_exp_f32 v125, v125
  v_exp_f32 v126, v126
  v_exp_f32 v127, v127
  v_cvt_pk_bf16_f32 v138, v124, v125
  v_cvt_pk_bf16_f32 v139, v126, v127
  v_mfma_f32_32x32x16_bf16 v[104:119], v[196:199], v[28:31], v[104:119]
  v_exp_f32 v128, v128
  v_exp_f32 v129, v129
  v_exp_f32 v130, v130
  v_exp_f32 v131, v131
  v_cvt_pk_bf16_f32 v140, v128, v129
  v_cvt_pk_bf16_f32 v141, v130, v131
  v_mfma_f32_32x32x16_bf16 v[56:71], v[200:203], v[136:139], v[56:71]
  v_exp_f32 v132, v132
  v_exp_f32 v133, v133
  v_exp_f32 v134, v134
  v_exp_f32 v135, v135
  v_cvt_pk_bf16_f32 v142, v132, v133
  v_cvt_pk_bf16_f32 v143, v134, v135
  v_mfma_f32_32x32x16_bf16 v[120:135], v[192:195], v[32:35], 0
  ds_write_b128 v4, v[40:43] offset:0
  v_exp_f32 v104, v104
  v_exp_f32 v105, v105
  v_exp_f32 v106, v106
  v_exp_f32 v107, v107
  v_cvt_pk_bf16_f32 v136, v104, v105
  v_cvt_pk_bf16_f32 v137, v106, v107
  v_mfma_f32_32x32x16_bf16 v[56:71], v[204:207], v[140:143], v[56:71]
  ds_write_b128 v4, v[44:47] offset:1024
  v_exp_f32 v108, v108
  v_exp_f32 v109, v109
  v_exp_f32 v110, v110
  v_exp_f32 v111, v111
  v_cvt_pk_bf16_f32 v138, v108, v109
  v_cvt_pk_bf16_f32 v139, v110, v111
  v_mfma_f32_32x32x16_bf16 v[120:135], v[196:199], v[36:39], v[120:135]
  ds_write_b128 v4, v[48:51] offset:2048
  v_exp_f32 v112, v112
  v_exp_f32 v113, v113
  v_exp_f32 v114, v114
  v_exp_f32 v115, v115
  v_cvt_pk_bf16_f32 v140, v112, v113
  v_cvt_pk_bf16_f32 v141, v114, v115
  v_mfma_f32_32x32x16_bf16 v[72:87], v[200:203], v[136:139], v[72:87]
  ds_write_b128 v4, v[52:55] offset:3072
  v_exp_f32 v116, v116
  v_exp_f32 v117, v117
  v_exp_f32 v118, v118
  v_exp_f32 v119, v119
  v_cvt_pk_bf16_f32 v142, v116, v117
  v_cvt_pk_bf16_f32 v143, v118, v119
  ds_write_b128 v5, v[56:59] offset:0
  v_exp_f32 v120, v120
  v_exp_f32 v121, v121
  v_exp_f32 v122, v122
  v_exp_f32 v123, v123
  v_cvt_pk_bf16_f32 v136, v120, v121
  v_cvt_pk_bf16_f32 v137, v122, v123
  v_mfma_f32_32x32x16_bf16 v[72:87], v[204:207], v[140:143], v[72:87]
  ds_write_b128 v5, v[60:63] offset:1024
  v_exp_f32 v124, v124
  v_exp_f32 v125, v125
  v_exp_f32 v126, v126
  v_exp_f32 v127, v127
  v_cvt_pk_bf16_f32 v138, v124, v125
  v_cvt_pk_bf16_f32 v139, v126, v127
  ds_write_b128 v5, v[64:67] offset:2048
  v_exp_f32 v128, v128
  v_exp_f32 v129, v129
  v_exp_f32 v130, v130
  v_exp_f32 v131, v131
  v_cvt_pk_bf16_f32 v140, v128, v129
  v_cvt_pk_bf16_f32 v141, v130, v131
  v_mfma_f32_32x32x16_bf16 v[88:103], v[200:203], v[136:139], v[88:103]
  ds_write_b128 v5, v[68:71] offset:3072
  v_exp_f32 v132, v132
  v_exp_f32 v133, v133
  v_exp_f32 v134, v134
  v_exp_f32 v135, v135
  v_cvt_pk_bf16_f32 v142, v132, v133
  v_cvt_pk_bf16_f32 v143, v134, v135
  s_nop 1
  v_mfma_f32_32x32x16_bf16 v[88:103], v[204:207], v[140:143], v[88:103]
  ds_write_b128 v6, v[72:75] offset:0
  ds_write_b128 v6, v[76:79] offset:1024
  ds_write_b128 v6, v[80:83] offset:2048
  ds_write_b128 v6, v[84:87] offset:3072
  v_mov_b32 v104, 0x53800000
  v_mov_b32 v105, 0x2b800000
  s_add_u32 s26, s63, 1
  s_nop 0
  v_mov_b32 v112, 0
  v_mov_b32 v113, s26
  s_cmp_lg_u32 s34, 0
  s_cbranch_scc1 L_NOFLAG
  v_min3_f32 v107, v52, v68, v84
  v_add_f32 v108, v52, v68
  v_add_f32 v109, v84, v100
  v_min_f32 v107, v107, v100
  v_add_f32 v108, v108, v109
  v_cmp_nlt_f32 vcc, v108, v104
  v_cmp_nge_f32 s[40:41], v107, v105
  s_cmp_eq_u32 s3, 0
  s_cselect_b32 s41, s41, 0
  s_or_b32 s41, s41, vcc_hi
  s_cbranch_scc0 L_NOFLAG
  v_mov_b32 v109, 155648
  v_mov_b32 v110, 1
  ds_write_b32 v109, v110
L_NOFLAG:
  v_mov_b32 v109, 155648
  s_waitcnt lgkmcnt(0)
  s_barrier
  ds_read_b32 v110, v109
  ds_read_b128 v[144:147], v7 offset:0
  ds_read_b128 v[148:151], v7 offset:1024
  ds_read_b128 v[152:155], v7 offset:2048
  ds_read_b128 v[156:159], v7 offset:3072
  ds_read_b128 v[160:163], v7 offset:4096
  ds_read_b128 v[164:167], v7 offset:5120
  ds_read_b128 v[168:171], v7 offset:6144
  ds_read_b128 v[172:175], v7 offset:7168
  ds_read_b128 v[176:179], v7 offset:8192
  ds_read_b128 v[180:183], v7 offset:9216
  ds_read_b128 v[184:187], v7 offset:10240
  ds_read_b128 v[188:191], v7 offset:11264
  s_waitcnt lgkmcnt(12)
  v_readfirstlane_b32 s26, v110
  s_nop 3
  s_cmp_gt_u32 s26, s34
  s_cbranch_scc1 L_FALLBACK
  s_mov_b64 exec, 1
  buffer_store_dword v113, v112, s[8:11], s33 offen sc1
  s_mov_b64 exec, -1
  s_waitcnt lgkmcnt(11)
  v_pk_add_f32 v[88:89], v[88:89], v[144:145]
  v_pk_add_f32 v[90:91], v[90:91], v[146:147]
  s_waitcnt lgkmcnt(10)
  v_pk_add_f32 v[92:93], v[92:93], v[148:149]
  v_pk_add_f32 v[94:95], v[94:95], v[150:151]
  s_waitcnt lgkmcnt(9)
  v_pk_add_f32 v[96:97], v[96:97], v[152:153]
  v_pk_add_f32 v[98:99], v[98:99], v[154:155]
  s_waitcnt lgkmcnt(8)
  v_pk_add_f32 v[100:101], v[100:101], v[156:157]
  v_pk_add_f32 v[102:103], v[102:103], v[158:159]
  s_waitcnt lgkmcnt(7)
  v_pk_add_f32 v[88:89], v[88:89], v[160:161]
  v_pk_add_f32 v[90:91], v[90:91], v[162:163]
  s_waitcnt lgkmcnt(6)
  v_pk_add_f32 v[92:93], v[92:93], v[164:165]
  v_pk_add_f32 v[94:95], v[94:95], v[166:167]
  s_waitcnt lgkmcnt(5)
  v_pk_add_f32 v[96:97], v[96:97], v[168:169]
  v_pk_add_f32 v[98:99], v[98:99], v[170:171]
  s_waitcnt lgkmcnt(4)
  v_pk_add_f32 v[100:101], v[100:101], v[172:173]
  v_pk_add_f32 v[102:103], v[102:103], v[174:175]
  s_waitcnt lgkmcnt(3)
  v_pk_add_f32 v[88:89], v[88:89], v[176:177]
  v_pk_add_f32 v[90:91], v[90:91], v[178:179]
  s_waitcnt lgkmcnt(2)
  v_pk_add_f32 v[92:93], v[92:93], v[180:181]
  v_pk_add_f32 v[94:95], v[94:95], v[182:183]
  s_waitcnt lgkmcnt(1)
  v_pk_add_f32 v[96:97], v[96:97], v[184:185]
  v_pk_add_f32 v[98:99], v[98:99], v[186:187]
  s_waitcnt lgkmcnt(0)
  v_pk_add_f32 v[100:101], v[100:101], v[188:189]
  v_pk_add_f32 v[102:103], v[102:103], v[190:191]
  v_mov_b32 v104, v100
  v_mov_b32 v105, v100
  s_nop 1
  v_permlane32_swap_b32 v104, v105
  s_nop 0
  v_rcp_f32 v106, v105
  s_nop 0
  v_mov_b32 v107, v106
  v_pk_mul_f32 v[88:89], v[88:89], v[106:107]
  v_pk_mul_f32 v[90:91], v[90:91], v[106:107]
  v_pk_mul_f32 v[92:93], v[92:93], v[106:107]
  v_pk_mul_f32 v[94:95], v[94:95], v[106:107]
  v_pk_mul_f32 v[96:97], v[96:97], v[106:107]
  v_pk_mul_f32 v[98:99], v[98:99], v[106:107]
  v_pk_mul_f32 v[100:101], v[100:101], v[106:107]
  v_pk_mul_f32 v[102:103], v[102:103], v[106:107]
  v_cvt_pk_bf16_f32 v144, v88, v89
  v_cvt_pk_bf16_f32 v145, v90, v91
  v_cvt_pk_bf16_f32 v146, v92, v93
  v_cvt_pk_bf16_f32 v147, v94, v95
  v_cvt_pk_bf16_f32 v148, v96, v97
  v_cvt_pk_bf16_f32 v149, v98, v99
  v_cvt_pk_bf16_f32 v150, v100, v101
  v_cvt_pk_bf16_f32 v151, v102, v103
  s_mov_b64 exec, s[28:29]
  v_mov_b32 v150, 0
  v_mov_b32 v151, 0
  s_mov_b64 exec, -1
  v_min_u32 v144, -2, v144
  v_min_u32 v145, -2, v145
  v_min_u32 v146, -2, v146
  v_min_u32 v147, -2, v147
  buffer_store_dwordx4 v[144:147], v3, s[8:11], s35 offen offset:0 sc1
  v_min_u32 v148, -2, v148
  v_min_u32 v149, -2, v149
  v_min_u32 v150, -2, v150
  v_min_u32 v151, -2, v151
  buffer_store_dwordx4 v[148:151], v3, s[8:11], s35 offen offset:1024 sc1
  s_branch L_END
L_FALLBACK:
  s_mov_b32 s34, 1
  s_waitcnt vmcnt(0) lgkmcnt(0)
  s_mov_b64 exec, s[28:29]
  v_mov_b32 v14, 0
  v_mov_b32 v15, 0
  v_mov_b32 v22, 0
  v_mov_b32 v23, 0
  v_mov_b32 v30, 0
  v_mov_b32 v31, 0
  v_mov_b32 v38, 0
  v_mov_b32 v39, 0
  s_mov_b64 exec, -1
  v_mov_b32 v216, 0xff800000
  v_mov_b32 v217, 0xff800000
  v_mov_b32 v218, 0xff800000
  v_mov_b32 v219, 0xff800000
  s_mov_b32 s31, 0
L_MAXLOOP:
  buffer_load_dwordx4 v[208:211], v3, s[12:15], s31 offen offset:0 sc1
  buffer_load_dwordx4 v[212:215], v3, s[12:15], s31 offen offset:1024 sc1
  s_waitcnt vmcnt(0)
  v_mfma_f32_32x32x16_bf16 v[40:55], v[208:211], v[8:11], 0
  v_mfma_f32_32x32x16_bf16 v[40:55], v[212:215], v[12:15], v[40:55]
  v_mfma_f32_32x32x16_bf16 v[56:71], v[208:211], v[16:19], 0
  v_mfma_f32_32x32x16_bf16 v[56:71], v[212:215], v[20:23], v[56:71]
  v_mfma_f32_32x32x16_bf16 v[72:87], v[208:211], v[24:27], 0
  v_mfma_f32_32x32x16_bf16 v[72:87], v[212:215], v[28:31], v[72:87]
  v_mfma_f32_32x32x16_bf16 v[88:103], v[208:211], v[32:35], 0
  v_mfma_f32_32x32x16_bf16 v[88:103], v[212:215], v[36:39], v[88:103]
  s_nop 7
  s_nop 7
  v_max3_f32 v216, v216, v40, v41
  v_max3_f32 v216, v216, v42, v43
  v_max3_f32 v216, v216, v44, v45
  v_max3_f32 v216, v216, v46, v47
  v_max3_f32 v216, v216, v48, v49
  v_max3_f32 v216, v216, v50, v51
  v_max3_f32 v216, v216, v52, v53
  v_max3_f32 v216, v216, v54, v55
  v_max3_f32 v217, v217, v56, v57
  v_max3_f32 v217, v217, v58, v59
  v_max3_f32 v217, v217, v60, v61
  v_max3_f32 v217, v217, v62, v63
  v_max3_f32 v217, v217, v64, v65
  v_max3_f32 v217, v217, v66, v67
  v_max3_f32 v217, v217, v68, v69
  v_max3_f32 v217, v217, v70, v71
  v_max3_f32 v218, v218, v72, v73
  v_max3_f32 v218, v218, v74, v75
  v_max3_f32 v218, v218, v76, v77
  v_max3_f32 v218, v218, v78, v79
  v_max3_f32 v218, v218, v80, v81
  v_max3_f32 v218, v218, v82, v83
  v_max3_f32 v218, v218, v84, v85
  v_max3_f32 v218, v218, v86, v87
  v_max3_f32 v219, v219, v88, v89
  v_max3_f32 v219, v219, v90, v91
  v_max3_f32 v219, v219, v92, v93
  v_max3_f32 v219, v219, v94, v95
  v_max3_f32 v219, v219, v96, v97
  v_max3_f32 v219, v219, v98, v99
  v_max3_f32 v219, v219, v100, v101
  v_max3_f32 v219, v219, v102, v103
  s_add_u32 s31, s31, 4096
  s_cmp_lt_u32 s31, 65536
  s_cbranch_scc1 L_MAXLOOP
  v_mov_b32 v220, v216
  v_mov_b32 v221, v217
  v_mov_b32 v222, v218
  v_mov_b32 v223, v219
  s_nop 1
  v_permlane32_swap_b32 v216, v220
  v_permlane32_swap_b32 v217, v221
  v_permlane32_swap_b32 v218, v222
  v_permlane32_swap_b32 v219, v223
  s_nop 1
  v_max_f32 v216, v216, v220
  v_max_f32 v217, v217, v221
  v_max_f32 v218, v218, v222
  v_max_f32 v219, v219, v223
  v_and_b32 v224, 31, v2
  v_lshlrev_b32 v224, 2, v224
  s_add_u32 s26, s3, 1
  s_and_b32 s26, s26, 3
  s_lshl_b32 s26, s26, 9
  s_add_u32 s26, s26, 155904
  v_add_u32 v225, s26, v224
  s_lshl_b32 s27, s3, 7
  v_add_u32 v229, s27, v225
  ds_write_b32 v229, v216
  s_add_u32 s26, s3, 2
  s_and_b32 s26, s26, 3
  s_lshl_b32 s26, s26, 9
  s_add_u32 s26, s26, 155904
  v_add_u32 v226, s26, v224
  s_lshl_b32 s27, s3, 7
  v_add_u32 v229, s27, v226
  ds_write_b32 v229, v217
  s_add_u32 s26, s3, 3
  s_and_b32 s26, s26, 3
  s_lshl_b32 s26, s26, 9
  s_add_u32 s26, s26, 155904
  v_add_u32 v227, s26, v224
  s_lshl_b32 s27, s3, 7
  v_add_u32 v229, s27, v227
  ds_write_b32 v229, v218
  s_add_u32 s26, s3, 4
  s_and_b32 s26, s26, 3
  s_lshl_b32 s26, s26, 9
  s_add_u32 s26, s26, 155904
  v_add_u32 v228, s26, v224
  s_lshl_b32 s27, s3, 7
  v_add_u32 v229, s27, v228
  ds_write_b32 v229, v219
  s_waitcnt lgkmcnt(0)
  s_barrier
  ds_read_b32 v40, v225 offset:0
  ds_read_b32 v41, v225 offset:128
  ds_read_b32 v42, v225 offset:256
  ds_read_b32 v43, v225 offset:384
  ds_read_b32 v44, v226 offset:0
  ds_read_b32 v45, v226 offset:128
  ds_read_b32 v46, v226 offset:256
  ds_read_b32 v47, v226 offset:384
  s_waitcnt lgkmcnt(0)
  ds_read_b32 v48, v227 offset:0
  ds_read_b32 v49, v227 offset:128
  ds_read_b32 v50, v227 offset:256
  ds_read_b32 v51, v227 offset:384
  ds_read_b32 v52, v228 offset:0
  ds_read_b32 v53, v228 offset:128
  ds_read_b32 v54, v228 offset:256
  ds_read_b32 v55, v228 offset:384
  s_waitcnt lgkmcnt(0)
  v_max3_f32 v40, v40, v41, v42
  v_max_f32 v40, v40, v43
  v_sub_f32 v40, 0, v40
  v_cvt_pk_bf16_f32 v41, v40, 0
  v_lshlrev_b32 v42, 16, v41
  v_sub_f32 v40, v40, v42
  v_cvt_pk_bf16_f32 v42, v40, 0
  v_lshlrev_b32 v43, 16, v42
  v_sub_f32 v40, v40, v43
  v_or_b32 v41, v41, v43
  v_cvt_pk_bf16_f32 v42, v40, 0
  v_max3_f32 v44, v44, v45, v46
  v_max_f32 v44, v44, v47
  v_sub_f32 v44, 0, v44
  v_cvt_pk_bf16_f32 v45, v44, 0
  v_lshlrev_b32 v46, 16, v45
  v_sub_f32 v44, v44, v46
  v_cvt_pk_bf16_f32 v46, v44, 0
  v_lshlrev_b32 v47, 16, v46
  v_sub_f32 v44, v44, v47
  v_or_b32 v45, v45, v47
  v_cvt_pk_bf16_f32 v46, v44, 0
  v_max3_f32 v48, v48, v49, v50
  v_max_f32 v48, v48, v51
  v_sub_f32 v48, 0, v48
  v_cvt_pk_bf16_f32 v49, v48, 0
  v_lshlrev_b32 v50, 16, v49
  v_sub_f32 v48, v48, v50
  v_cvt_pk_bf16_f32 v50, v48, 0
  v_lshlrev_b32 v51, 16, v50
  v_sub_f32 v48, v48, v51
  v_or_b32 v49, v49, v51
  v_cvt_pk_bf16_f32 v50, v48, 0
  v_max3_f32 v52, v52, v53, v54
  v_max_f32 v52, v52, v55
  v_sub_f32 v52, 0, v52
  v_cvt_pk_bf16_f32 v53, v52, 0
  v_lshlrev_b32 v54, 16, v53
  v_sub_f32 v52, v52, v54
  v_cvt_pk_bf16_f32 v54, v52, 0
  v_lshlrev_b32 v55, 16, v54
  v_sub_f32 v52, v52, v55
  v_or_b32 v53, v53, v55
  v_cvt_pk_bf16_f32 v54, v52, 0
  s_mov_b64 exec, s[28:29]
  v_mov_b32 v14, v41
  v_mov_b32 v15, v42
  v_mov_b32 v22, v45
  v_mov_b32 v23, v46
  v_mov_b32 v30, v49
  v_mov_b32 v31, v50
  v_mov_b32 v38, v53
  v_mov_b32 v39, v54
  s_mov_b64 exec, -1
  buffer_load_dwordx4 v[144:147], v248, s[12:15], 0 offen offset:0 sc1
  buffer_load_dwordx4 v[148:151], v248, s[12:15], 0 offen offset:1024 sc1
  buffer_load_dwordx4 v[152:155], v248, s[12:15], 0 offen offset:2048 sc1
  buffer_load_dwordx4 v[156:159], v248, s[12:15], 0 offen offset:3072 sc1
  buffer_load_dwordx4 v[160:163], v249, s[12:15], 0 offen offset:0 sc1
  buffer_load_dwordx4 v[164:167], v249, s[12:15], 0 offen offset:1024 sc1
  buffer_load_dwordx4 v[168:171], v249, s[12:15], 0 offen offset:2048 sc1
  buffer_load_dwordx4 v[172:175], v249, s[12:15], 0 offen offset:3072 sc1
  buffer_load_dwordx4 v[176:179], v250, s[12:15], 0 offen offset:0 sc1
  buffer_load_dwordx4 v[180:183], v250, s[12:15], 0 offen offset:1024 sc1
  buffer_load_dwordx4 v[184:187], v250, s[12:15], 0 offen offset:2048 sc1
  buffer_load_dwordx4 v[188:191], v250, s[12:15], 0 offen offset:3072 sc1
  buffer_load_dwordx4 v[192:195], v251, s[12:15], 0 offen offset:0 sc1
  buffer_load_dwordx4 v[196:199], v251, s[12:15], 0 offen offset:1024 sc1
  v_mov_b32 v40, 0
  v_mov_b32 v41, 0
  v_mov_b32 v42, 0
  v_mov_b32 v43, 0
  v_mov_b32 v44, 0
  v_mov_b32 v45, 0
  v_mov_b32 v46, 0
  v_mov_b32 v47, 0
  v_mov_b32 v48, 0
  v_mov_b32 v49, 0
  v_mov_b32 v50, 0
  v_mov_b32 v51, 0
  v_mov_b32 v52, 0
  v_mov_b32 v53, 0
  v_mov_b32 v54, 0
  v_mov_b32 v55, 0
  v_mov_b32 v56, 0
  v_mov_b32 v57, 0
  v_mov_b32 v58, 0
  v_mov_b32 v59, 0
  v_mov_b32 v60, 0
  v_mov_b32 v61, 0
  v_mov_b32 v62, 0
  v_mov_b32 v63, 0
  v_mov_b32 v64, 0
  v_mov_b32 v65, 0
  v_mov_b32 v66, 0
  v_mov_b32 v67, 0
  v_mov_b32 v68, 0
  v_mov_b32 v69, 0
  v_mov_b32 v70, 0
  v_mov_b32 v71, 0
  v_mov_b32 v72, 0
  v_mov_b32 v73, 0
  v_mov_b32 v74, 0
  v_mov_b32 v75, 0
  v_mov_b32 v76, 0
  v_mov_b32 v77, 0
  v_mov_b32 v78, 0
  v_mov_b32 v79, 0
  v_mov_b32 v80, 0
  v_mov_b32 v81, 0
  v_mov_b32 v82, 0
  v_mov_b32 v83, 0
  v_mov_b32 v84, 0
  v_mov_b32 v85, 0
  v_mov_b32 v86, 0
  v_mov_b32 v87, 0
  v_mov_b32 v88, 0
  v_mov_b32 v89, 0
  v_mov_b32 v90, 0
  v_mov_b32 v91, 0
  v_mov_b32 v92, 0
  v_mov_b32 v93, 0
  v_mov_b32 v94, 0
  v_mov_b32 v95, 0
  v_mov_b32 v96, 0
  v_mov_b32 v97, 0
  v_mov_b32 v98, 0
  v_mov_b32 v99, 0
  v_mov_b32 v100, 0
  v_mov_b32 v101, 0
  v_mov_b32 v102, 0
  v_mov_b32 v103, 0
  v_mov_b32 v204, 0
  v_mov_b32 v205, 0
  v_mov_b32 v206, 0
  v_mov_b32 v207, 0
  v_mov_b32 v140, 0
  v_mov_b32 v141, 0
  v_mov_b32 v142, 0
  v_mov_b32 v143, 0
  v_mov_b32 v208, 155648
  s_branch L_MAIN
L_END:
L_EXIT:
  s_endpgm
L_CODEEND:
.section .rodata,"a"
.p2align 6
.amdhsa_kernel standalone__mha_block__prompt_kernel
  .amdhsa_next_free_vgpr 256
  .amdhsa_next_free_sgpr 64
  .amdhsa_accum_offset 256
  .amdhsa_group_segment_fixed_size 0
  .amdhsa_kernarg_size 48
  .amdhsa_user_sgpr_count 2
  .amdhsa_user_sgpr_kernarg_segment_ptr 1
  .amdhsa_system_sgpr_workgroup_id_x 1
.end_amdhsa_kernel
```
